```python
import torch

def _softmax(x, axis=-1):
    return torch.softmax(x, dim=axis)
def _gelu(x):
    return torch.nn.functional.gelu(x, approximate="tanh")
def _silu(x):
    return torch.nn.functional.silu(x)
def _sigmoid(x):
    return torch.sigmoid(x)
def _layernorm(x, axis=-1, eps=1e-5):
    m = x.mean(dim=axis, keepdim=True)
    v = x.var(dim=axis, keepdim=True, unbiased=False)
    return (x - m) / torch.sqrt(v + eps)
def _scatter_add(tgt, idx, src, axis=0):
    return tgt.clone().index_add_(axis, idx, src)
def _segment_sum(src, seg, n):
    out = torch.zeros((n,) + src.shape[1:], dtype=src.dtype)
    return out.index_add_(0, seg, src)
def _pad(x, pw):
    flat = tuple(v for pair in reversed(pw) for v in pair)
    return torch.nn.functional.pad(x, flat)

kernel_name = 'concat_heads__mha_block_cached__gqa_block_cached__decode'

def setup_inputs():

    _w = (lambda a: (lambda t: t.to(torch.bfloat16) if t.is_floating_point() else t)(torch.as_tensor(a)))
    def _A_setup():
        B, Sq, D = 8, 1, 512
        H, Sk, Dh = 32, 4096, 128
        return {
            "x": _w((lambda *s: torch.randn(*s, dtype=torch.bfloat16) * 0.8)(B, Sq, D)),
            "k_cache": _w((lambda *s: torch.randn(*s, dtype=torch.bfloat16) * 0.8)(B, H, Sk, Dh)),
            "v_cache": _w((lambda *s: torch.randn(*s, dtype=torch.bfloat16) * 0.05)(B, H, Sk, Dh)),
            "wq": _w((lambda *s: torch.randn(*s, dtype=torch.bfloat16) * 0.8)(D, H * Dh) * (D ** -0.5)),
            "wo": _w((lambda *s: torch.randn(*s, dtype=torch.bfloat16) * 0.05)(H * Dh, D) * ((H * Dh) ** -0.5)),
        }
    _A_in = _A_setup()

    def _B_setup():
        B, Sq, D = 8, 1, 512
        Hq, Hkv, Sk, Dh = 32, 8, 4096, 128
        assert Hq % Hkv == 0, (Hq, Hkv)
        return {
            "x": _w((lambda *s: torch.randn(*s, dtype=torch.bfloat16) * 0.8)(B, Sq, D)),
            "k_cache": _w((lambda *s: torch.randn(*s, dtype=torch.bfloat16) * 0.8)(B, Hkv, Sk, Dh)),
            "v_cache": _w((lambda *s: torch.randn(*s, dtype=torch.bfloat16) * 0.05)(B, Hkv, Sk, Dh)),
            "wq": _w((lambda *s: torch.randn(*s, dtype=torch.bfloat16) * 0.8)(D, Hq * Dh) * (D ** -0.5)),
            "wo": _w((lambda *s: torch.randn(*s, dtype=torch.bfloat16) * 0.05)(Hq * Dh, D) * ((Hq * Dh) ** -0.5)),
        }
    _B_in = _B_setup()

    return {
        "A_x": _A_in["x"],
        "A_k_cache": _A_in["k_cache"],
        "A_v_cache": _A_in["v_cache"],
        "A_wq": _A_in["wq"],
        "A_wo": _A_in["wo"],
        "B_x": _B_in["x"],
        "B_k_cache": _B_in["k_cache"],
        "B_v_cache": _B_in["v_cache"],
        "B_wq": _B_in["wq"],
        "B_wo": _B_in["wo"],
    }

def reference(A_x, A_k_cache, A_v_cache, A_wq, A_wo, B_x, B_k_cache, B_v_cache, B_wq, B_wo):
    def _A_ref(x, k_cache, v_cache, wq, wo):
        B, Sq, D = x.shape
        H, Dh = 32, 128
        q = (lambda x, *d: x.permute(*d))((x @ wq).reshape(B, Sq, H, Dh), 0, 2, 1, 3)
        scores = torch.einsum("bhqd,bhkd->bhqk", q, k_cache) * (Dh ** -0.5)
        p = _softmax(scores, axis=-1)
        o = torch.einsum("bhqk,bhkd->bhqd", p, v_cache)
        return (lambda x, *d: x.permute(*d))(o, 0, 2, 1, 3).reshape(B, Sq, H * Dh) @ wo

    def _B_ref(x, k_cache, v_cache, wq, wo):
        B, Sq, D = x.shape
        Hq, Dh = 32, 128
        Hkv = k_cache.shape[1]
        rep = Hq // Hkv
        q = (lambda x, *d: x.permute(*d))((x @ wq).reshape(B, Sq, Hq, Dh), 0, 2, 1, 3)
        k = (lambda x, n, axis: torch.repeat_interleave(x, n, dim=axis))(k_cache, rep, axis=1)
        v = (lambda x, n, axis: torch.repeat_interleave(x, n, dim=axis))(v_cache, rep, axis=1)
        scores = torch.einsum("bhqd,bhkd->bhqk", q, k) * (Dh ** -0.5)
        p = _softmax(scores, axis=-1)
        o = torch.einsum("bhqk,bhkd->bhqd", p, v)
        return (lambda x, *d: x.permute(*d))(o, 0, 2, 1, 3).reshape(B, Sq, Hq * Dh) @ wo

    a = _A_ref(A_x, A_k_cache, A_v_cache, A_wq, A_wo)
    b = _B_ref(B_x, B_k_cache, B_v_cache, B_wq, B_wo)
    return torch.concatenate([a, b], axis=-1)
```

```asm
; @launch grid=(256,1,1) block=(512,1,1) lds=151552
.amdgcn_target "amdgcn-amd-amdhsa--gfx950"
.text
.globl concat_heads__mha_block_cached__gqa_block_cached__decode_kernel
.p2align 8
.type concat_heads__mha_block_cached__gqa_block_cached__decode_kernel,@function
concat_heads__mha_block_cached__gqa_block_cached__decode_kernel:
  s_cmp_ge_u32 s2, 256
  s_cbranch_scc1 L_end
  s_load_dwordx16 s[4:19], s[0:1], 0
  s_load_dwordx8 s[20:27], s[0:1], 64
  s_load_dwordx2 s[28:29], s[0:1], 96
  v_lshrrev_b32 v1, 6, v0
  v_and_b32 v2, 63, v0
  s_and_b32 s61, s2, 7
  s_lshl_b32 s61, s61, 2
  s_bfe_u32 s30, s2, 0x20003
  s_add_u32 s61, s61, s30
  s_lshr_b32 s3, s2, 1
  s_xor_b32 s3, s3, s2
  s_and_b32 s3, s3, 1
  s_lshl_b32 s3, s3, 2
  s_xor_b32 s2, s2, s3
  v_readfirstlane_b32 s3, v1
  s_and_b32 s30, s2, 3
  s_and_b32 s31, s2, 31
  s_lshr_b32 s60, s2, 5
  s_cmp_ge_u32 s3, 4
  s_cbranch_scc1 L_helper
  v_lshlrev_b32 v1, 4, v0
  s_mul_i32 s42, s3, 3072
  v_add_u32 v1, s42, v1
  s_lshl_b32 s40, s60, 5
  s_add_u32 s40, s40, s61
  s_lshl_b32 s40, s40, 20
  s_mov_b32 s34, 268435456
  s_mov_b32 s35, 0x00020000
  s_mov_b32 s38, 268435456
  s_mov_b32 s39, 0x00020000
  s_waitcnt lgkmcnt(0)
  s_mov_b64 s[32:33], s[6:7]
  s_mov_b64 s[36:37], s[8:9]
  buffer_load_dwordx4 v[128:131], v1, s[32:35], s40 offen offset:0 nt
  buffer_load_dwordx4 v[132:135], v1, s[32:35], s40 offen offset:1024 nt
  buffer_load_dwordx4 v[136:139], v1, s[32:35], s40 offen offset:2048 nt
  buffer_load_dwordx4 v[140:143], v1, s[32:35], s40 offen offset:3072 nt
  s_barrier
  buffer_load_dwordx4 v[144:147], v1, s[36:39], s40 offen offset:0 nt
  buffer_load_dwordx4 v[148:151], v1, s[36:39], s40 offen offset:1024 nt
  buffer_load_dwordx4 v[152:155], v1, s[36:39], s40 offen offset:2048 nt
  buffer_load_dwordx4 v[156:159], v1, s[36:39], s40 offen offset:3072 nt
  s_add_u32 s42, s40, 16384
  buffer_load_dwordx4 v[160:163], v1, s[32:35], s42 offen offset:0 nt
  buffer_load_dwordx4 v[164:167], v1, s[32:35], s42 offen offset:1024 nt
  buffer_load_dwordx4 v[168:171], v1, s[32:35], s42 offen offset:2048 nt
  buffer_load_dwordx4 v[172:175], v1, s[32:35], s42 offen offset:3072 nt
  s_add_u32 s42, s40, 16384
  buffer_load_dwordx4 v[176:179], v1, s[36:39], s42 offen offset:0 nt
  buffer_load_dwordx4 v[180:183], v1, s[36:39], s42 offen offset:1024 nt
  buffer_load_dwordx4 v[184:187], v1, s[36:39], s42 offen offset:2048 nt
  buffer_load_dwordx4 v[188:191], v1, s[36:39], s42 offen offset:3072 nt
  s_add_u32 s42, s40, 32768
  buffer_load_dwordx4 v[64:67], v1, s[32:35], s42 offen offset:0 nt
  buffer_load_dwordx4 v[68:71], v1, s[32:35], s42 offen offset:1024 nt
  buffer_load_dwordx4 v[72:75], v1, s[32:35], s42 offen offset:2048 nt
  buffer_load_dwordx4 v[76:79], v1, s[32:35], s42 offen offset:3072 nt
  s_add_u32 s42, s40, 32768
  buffer_load_dwordx4 v[80:83], v1, s[36:39], s42 offen offset:0 nt
  buffer_load_dwordx4 v[84:87], v1, s[36:39], s42 offen offset:1024 nt
  buffer_load_dwordx4 v[88:91], v1, s[36:39], s42 offen offset:2048 nt
  buffer_load_dwordx4 v[92:95], v1, s[36:39], s42 offen offset:3072 nt
  s_add_u32 s42, s40, 49152
  buffer_load_dwordx4 v[96:99], v1, s[32:35], s42 offen offset:0 nt
  buffer_load_dwordx4 v[100:103], v1, s[32:35], s42 offen offset:1024 nt
  buffer_load_dwordx4 v[104:107], v1, s[32:35], s42 offen offset:2048 nt
  buffer_load_dwordx4 v[108:111], v1, s[32:35], s42 offen offset:3072 nt
  s_add_u32 s40, s40, 32768
  s_lshr_b32 s44, s2, 2
  s_lshl_b32 s44, s44, 20
  s_lshr_b32 s42, s2, 2
  s_mul_i32 s42, s42, 16384
  s_add_u32 s42, s42, 3145728
  s_add_u32 s46, s28, s42
  s_addc_u32 s47, s29, 0
  s_mov_b32 s43, 0x3fb8aa3b
  s_mov_b32 s52, 0x3db504f3
  s_mov_b32 s53, 0xffff0000
  v_and_b32 v18, 1, v2
  v_cmp_eq_u32 vcc, 1, v18
  v_mov_b32 v18, 0xffff
  v_mov_b32 v19, 0xffff0000
  v_cndmask_b32 v18, v18, v19, vcc
  v_bfe_u32 v19, v2, 1, 3
  v_cmp_eq_u32 vcc, 0, v19
  s_nop 1
  v_cndmask_b32 v8, 0, v18, vcc
  v_cmp_eq_u32 vcc, 1, v19
  s_nop 1
  v_cndmask_b32 v9, 0, v18, vcc
  v_cmp_eq_u32 vcc, 2, v19
  s_nop 1
  v_cndmask_b32 v10, 0, v18, vcc
  v_cmp_eq_u32 vcc, 3, v19
  s_nop 1
  v_cndmask_b32 v11, 0, v18, vcc
  v_cmp_eq_u32 vcc, 4, v19
  s_nop 1
  v_cndmask_b32 v12, 0, v18, vcc
  v_cmp_eq_u32 vcc, 5, v19
  s_nop 1
  v_cndmask_b32 v13, 0, v18, vcc
  v_cmp_eq_u32 vcc, 6, v19
  s_nop 1
  v_cndmask_b32 v14, 0, v18, vcc
  v_cmp_eq_u32 vcc, 7, v19
  s_nop 1
  v_cndmask_b32 v15, 0, v18, vcc
  v_mov_b32 v16, 0xff800000
  v_mov_b32 v17, 0
  v_and_b32 v3, 15, v2
  v_lshlrev_b32 v3, 5, v3
  v_bfe_u32 v40, v2, 2, 2
  v_lshrrev_b32 v41, 4, v2
  v_and_b32 v42, 3, v2
  v_lshlrev_b32 v41, 7, v41
  v_lshl_add_u32 v41, v42, 2, v41
  v_lshl_add_u32 v28, v40, 5, v41
  v_lshl_add_u32 v29, v40, 9, v41
  s_lshl_b32 s42, s3, 9
  v_add_u32 v28, s42, v28
  s_lshl_b32 s42, s3, 11
  v_add_u32 v29, s42, v29
  s_lshl_b32 s42, s3, 2
  v_mov_b32 v21, s42
  v_lshl_add_u32 v30, v40, 5, v21
  s_barrier
  ds_read_b128 v[32:35], v3 offset:0
  ds_read_b128 v[36:39], v3 offset:16
  ds_read_b128 v[40:43], v3 offset:512
  ds_read_b128 v[44:47], v3 offset:528
  ds_read_b128 v[48:51], v3 offset:1024
  ds_read_b128 v[52:55], v3 offset:1040
  ds_read_b128 v[56:59], v3 offset:1536
  ds_read_b128 v[60:63], v3 offset:1552
  s_waitcnt lgkmcnt(0)
  v_pk_add_f32 v[32:33], v[32:33], v[40:41]
  v_pk_add_f32 v[48:49], v[48:49], v[56:57]
  v_pk_add_f32 v[34:35], v[34:35], v[42:43]
  v_pk_add_f32 v[50:51], v[50:51], v[58:59]
  v_pk_add_f32 v[36:37], v[36:37], v[44:45]
  v_pk_add_f32 v[52:53], v[52:53], v[60:61]
  v_pk_add_f32 v[38:39], v[38:39], v[46:47]
  v_pk_add_f32 v[54:55], v[54:55], v[62:63]
  v_pk_add_f32 v[32:33], v[32:33], v[48:49]
  v_pk_add_f32 v[34:35], v[34:35], v[50:51]
  v_pk_add_f32 v[36:37], v[36:37], v[52:53]
  v_pk_add_f32 v[38:39], v[38:39], v[54:55]
  v_cvt_pk_bf16_f32 v4, v32, v33
  v_cvt_pk_bf16_f32 v5, v34, v35
  v_cvt_pk_bf16_f32 v6, v36, v37
  v_cvt_pk_bf16_f32 v7, v38, v39
  v_mov_b32 v32, 0
  v_mov_b32 v33, 0
  v_mov_b32 v34, 0
  v_mov_b32 v35, 0
  v_mov_b32 v36, 0
  v_mov_b32 v37, 0
  v_mov_b32 v38, 0
  v_mov_b32 v39, 0
  s_waitcnt vmcnt(24)
  v_dot2_f32_bf16 v40, v128, v4, 0
  v_dot2_f32_bf16 v41, v132, v4, 0
  v_dot2_f32_bf16 v42, v136, v4, 0
  v_dot2_f32_bf16 v43, v140, v4, 0
  v_dot2c_f32_bf16 v40, v129, v5
  v_dot2c_f32_bf16 v41, v133, v5
  v_dot2c_f32_bf16 v42, v137, v5
  v_dot2c_f32_bf16 v43, v141, v5
  v_dot2c_f32_bf16 v40, v130, v6
  v_dot2c_f32_bf16 v41, v134, v6
  v_dot2c_f32_bf16 v42, v138, v6
  v_dot2c_f32_bf16 v43, v142, v6
  v_dot2c_f32_bf16 v40, v131, v7
  v_dot2c_f32_bf16 v41, v135, v7
  v_dot2c_f32_bf16 v42, v139, v7
  v_dot2c_f32_bf16 v43, v143, v7
  v_add_f32_dpp v44, v40, v40 row_ror:8 row_mask:0xf bank_mask:0x3
  v_add_f32_dpp v45, v41, v41 row_ror:8 row_mask:0xf bank_mask:0x3
  v_add_f32_dpp v44, v42, v42 row_ror:8 row_mask:0xf bank_mask:0xc
  v_add_f32_dpp v45, v43, v43 row_ror:8 row_mask:0xf bank_mask:0xc
  s_nop 0
  v_add_f32_dpp v52, v44, v44 row_shl:4 row_mask:0xf bank_mask:0x5
  v_add_f32_dpp v52, v45, v45 row_shr:4 row_mask:0xf bank_mask:0xa
  s_nop 1
  v_add_f32_dpp v52, v52, v52 quad_perm:[1,0,3,2] row_mask:0xf bank_mask:0xf
  s_nop 1
  v_add_f32_dpp v52, v52, v52 quad_perm:[2,3,0,1] row_mask:0xf bank_mask:0xf
  v_cvt_pk_bf16_f32 v52, v52, v52
  v_and_b32 v52, s53, v52
  v_mul_f32 v52, s52, v52
  v_cvt_pk_bf16_f32 v52, v52, v52
  v_and_b32 v52, s53, v52
  v_mul_f32 v40, s43, v52
  v_mul_f32 v18, s43, v52
  v_mul_f32 v19, s43, v52
  s_nop 1
  v_permlane16_swap_b32 v18, v19
  v_max_f32 v18, v18, v19
  v_mov_b32 v19, v18
  s_nop 1
  v_permlane32_swap_b32 v18, v19
  v_max3_f32 v20, v18, v19, v16
  v_sub_f32 v22, v16, v20
  v_sub_f32 v24, v40, v20
  v_exp_f32 v22, v22
  v_exp_f32 v24, v24
  v_mov_b32 v16, v20
  v_fma_f32 v17, v17, v22, v24
  v_pk_mul_f32 v[32:33], v[32:33], v[22:23] op_sel_hi:[1,0]
  v_pk_mul_f32 v[34:35], v[34:35], v[22:23] op_sel_hi:[1,0]
  v_pk_mul_f32 v[36:37], v[36:37], v[22:23] op_sel_hi:[1,0]
  v_pk_mul_f32 v[38:39], v[38:39], v[22:23] op_sel_hi:[1,0]
  v_cvt_pk_bf16_f32 v18, v24, v24
  v_and_b32 v56, v18, v8
  v_and_b32 v57, v18, v9
  v_and_b32 v58, v18, v10
  v_and_b32 v59, v18, v11
  v_and_b32 v60, v18, v12
  v_and_b32 v61, v18, v13
  v_and_b32 v62, v18, v14
  v_and_b32 v63, v18, v15
  s_waitcnt vmcnt(20)
  s_nop 0
  v_mfma_f32_16x16x16_bf16 v[32:35], v[144:145], v[56:57], v[32:35]
  v_mfma_f32_16x16x16_bf16 v[36:39], v[146:147], v[56:57], v[36:39]
  v_mfma_f32_16x16x16_bf16 v[32:35], v[148:149], v[58:59], v[32:35]
  v_mfma_f32_16x16x16_bf16 v[36:39], v[150:151], v[58:59], v[36:39]
  v_mfma_f32_16x16x16_bf16 v[32:35], v[152:153], v[60:61], v[32:35]
  v_mfma_f32_16x16x16_bf16 v[36:39], v[154:155], v[60:61], v[36:39]
  v_mfma_f32_16x16x16_bf16 v[32:35], v[156:157], v[62:63], v[32:35]
  v_mfma_f32_16x16x16_bf16 v[36:39], v[158:159], v[62:63], v[36:39]
  s_waitcnt vmcnt(16)
  v_dot2_f32_bf16 v40, v160, v4, 0
  v_dot2_f32_bf16 v41, v164, v4, 0
  v_dot2_f32_bf16 v42, v168, v4, 0
  v_dot2_f32_bf16 v43, v172, v4, 0
  v_dot2c_f32_bf16 v40, v161, v5
  v_dot2c_f32_bf16 v41, v165, v5
  v_dot2c_f32_bf16 v42, v169, v5
  v_dot2c_f32_bf16 v43, v173, v5
  v_dot2c_f32_bf16 v40, v162, v6
  v_dot2c_f32_bf16 v41, v166, v6
  v_dot2c_f32_bf16 v42, v170, v6
  v_dot2c_f32_bf16 v43, v174, v6
  v_dot2c_f32_bf16 v40, v163, v7
  v_dot2c_f32_bf16 v41, v167, v7
  v_dot2c_f32_bf16 v42, v171, v7
  v_dot2c_f32_bf16 v43, v175, v7
  v_add_f32_dpp v44, v40, v40 row_ror:8 row_mask:0xf bank_mask:0x3
  v_add_f32_dpp v45, v41, v41 row_ror:8 row_mask:0xf bank_mask:0x3
  v_add_f32_dpp v44, v42, v42 row_ror:8 row_mask:0xf bank_mask:0xc
  v_add_f32_dpp v45, v43, v43 row_ror:8 row_mask:0xf bank_mask:0xc
  s_nop 0
  v_add_f32_dpp v52, v44, v44 row_shl:4 row_mask:0xf bank_mask:0x5
  v_add_f32_dpp v52, v45, v45 row_shr:4 row_mask:0xf bank_mask:0xa
  s_nop 1
  v_add_f32_dpp v52, v52, v52 quad_perm:[1,0,3,2] row_mask:0xf bank_mask:0xf
  s_nop 1
  v_add_f32_dpp v52, v52, v52 quad_perm:[2,3,0,1] row_mask:0xf bank_mask:0xf
  v_cvt_pk_bf16_f32 v52, v52, v52
  v_and_b32 v52, s53, v52
  v_mul_f32 v52, s52, v52
  v_cvt_pk_bf16_f32 v52, v52, v52
  v_and_b32 v52, s53, v52
  v_mul_f32 v40, s43, v52
  v_mul_f32 v18, s43, v52
  v_mul_f32 v19, s43, v52
  s_nop 1
  v_permlane16_swap_b32 v18, v19
  v_max_f32 v18, v18, v19
  v_mov_b32 v19, v18
  s_nop 1
  v_permlane32_swap_b32 v18, v19
  v_max3_f32 v20, v18, v19, v16
  v_sub_f32 v22, v16, v20
  v_sub_f32 v24, v40, v20
  v_exp_f32 v22, v22
  v_exp_f32 v24, v24
  v_mov_b32 v16, v20
  v_fma_f32 v17, v17, v22, v24
  v_pk_mul_f32 v[32:33], v[32:33], v[22:23] op_sel_hi:[1,0]
  v_pk_mul_f32 v[34:35], v[34:35], v[22:23] op_sel_hi:[1,0]
  v_pk_mul_f32 v[36:37], v[36:37], v[22:23] op_sel_hi:[1,0]
  v_pk_mul_f32 v[38:39], v[38:39], v[22:23] op_sel_hi:[1,0]
  v_cvt_pk_bf16_f32 v18, v24, v24
  v_and_b32 v56, v18, v8
  v_and_b32 v57, v18, v9
  v_and_b32 v58, v18, v10
  v_and_b32 v59, v18, v11
  v_and_b32 v60, v18, v12
  v_and_b32 v61, v18, v13
  v_and_b32 v62, v18, v14
  v_and_b32 v63, v18, v15
  s_waitcnt vmcnt(12)
  s_nop 0
  v_mfma_f32_16x16x16_bf16 v[32:35], v[176:177], v[56:57], v[32:35]
  v_mfma_f32_16x16x16_bf16 v[36:39], v[178:179], v[56:57], v[36:39]
  v_mfma_f32_16x16x16_bf16 v[32:35], v[180:181], v[58:59], v[32:35]
  v_mfma_f32_16x16x16_bf16 v[36:39], v[182:183], v[58:59], v[36:39]
  v_mfma_f32_16x16x16_bf16 v[32:35], v[184:185], v[60:61], v[32:35]
  v_mfma_f32_16x16x16_bf16 v[36:39], v[186:187], v[60:61], v[36:39]
  v_mfma_f32_16x16x16_bf16 v[32:35], v[188:189], v[62:63], v[32:35]
  v_mfma_f32_16x16x16_bf16 v[36:39], v[190:191], v[62:63], v[36:39]
  s_mov_b32 s41, 30
  s_mov_b64 s[48:49], 0
L_loopA:
  s_waitcnt vmcnt(8)
  v_dot2_f32_bf16 v40, v64, v4, 0
  v_dot2_f32_bf16 v41, v68, v4, 0
  v_dot2_f32_bf16 v42, v72, v4, 0
  v_dot2_f32_bf16 v43, v76, v4, 0
  v_dot2c_f32_bf16 v40, v65, v5
  v_dot2c_f32_bf16 v41, v69, v5
  v_dot2c_f32_bf16 v42, v73, v5
  v_dot2c_f32_bf16 v43, v77, v5
  v_dot2c_f32_bf16 v40, v66, v6
  v_dot2c_f32_bf16 v41, v70, v6
  v_dot2c_f32_bf16 v42, v74, v6
  v_dot2c_f32_bf16 v43, v78, v6
  v_dot2c_f32_bf16 v40, v67, v7
  v_dot2c_f32_bf16 v41, v71, v7
  v_dot2c_f32_bf16 v42, v75, v7
  v_dot2c_f32_bf16 v43, v79, v7
  v_add_f32_dpp v44, v40, v40 row_ror:8 row_mask:0xf bank_mask:0x3
  v_add_f32_dpp v45, v41, v41 row_ror:8 row_mask:0xf bank_mask:0x3
  v_add_f32_dpp v44, v42, v42 row_ror:8 row_mask:0xf bank_mask:0xc
  v_add_f32_dpp v45, v43, v43 row_ror:8 row_mask:0xf bank_mask:0xc
  s_nop 0
  v_add_f32_dpp v52, v44, v44 row_shl:4 row_mask:0xf bank_mask:0x5
  v_add_f32_dpp v52, v45, v45 row_shr:4 row_mask:0xf bank_mask:0xa
  s_nop 1
  v_add_f32_dpp v52, v52, v52 quad_perm:[1,0,3,2] row_mask:0xf bank_mask:0xf
  s_nop 1
  v_add_f32_dpp v52, v52, v52 quad_perm:[2,3,0,1] row_mask:0xf bank_mask:0xf
  v_cvt_pk_bf16_f32 v52, v52, v52
  v_and_b32 v52, s53, v52
  v_mul_f32 v52, s52, v52
  v_cvt_pk_bf16_f32 v52, v52, v52
  v_and_b32 v52, s53, v52
  v_mul_f32 v40, s43, v52
  v_mul_f32 v18, s43, v52
  v_mul_f32 v19, s43, v52
  s_nop 1
  v_permlane16_swap_b32 v18, v19
  v_max_f32 v18, v18, v19
  v_mov_b32 v19, v18
  s_nop 1
  v_permlane32_swap_b32 v18, v19
  v_max3_f32 v20, v18, v19, v16
  v_sub_f32 v22, v16, v20
  v_sub_f32 v24, v40, v20
  v_exp_f32 v22, v22
  v_exp_f32 v24, v24
  v_mov_b32 v16, v20
  v_fma_f32 v17, v17, v22, v24
  v_pk_mul_f32 v[32:33], v[32:33], v[22:23] op_sel_hi:[1,0]
  v_pk_mul_f32 v[34:35], v[34:35], v[22:23] op_sel_hi:[1,0]
  v_pk_mul_f32 v[36:37], v[36:37], v[22:23] op_sel_hi:[1,0]
  v_pk_mul_f32 v[38:39], v[38:39], v[22:23] op_sel_hi:[1,0]
  v_cvt_pk_bf16_f32 v18, v24, v24
  v_and_b32 v56, v18, v8
  v_and_b32 v57, v18, v9
  v_and_b32 v58, v18, v10
  v_and_b32 v59, v18, v11
  v_and_b32 v60, v18, v12
  v_and_b32 v61, v18, v13
  v_and_b32 v62, v18, v14
  v_and_b32 v63, v18, v15
  s_waitcnt vmcnt(4)
  s_add_u32 s42, s40, 16384
  buffer_load_dwordx4 v[112:115], v1, s[36:39], s42 offen offset:0 nt
  buffer_load_dwordx4 v[116:119], v1, s[36:39], s42 offen offset:1024 nt
  buffer_load_dwordx4 v[120:123], v1, s[36:39], s42 offen offset:2048 nt
  buffer_load_dwordx4 v[124:127], v1, s[36:39], s42 offen offset:3072 nt
  s_waitcnt vmcnt(8)
  s_add_u32 s40, s40, 32768
  s_cmp_lg_u32 s41, 4
  s_cbranch_scc1 L_nb
  s_barrier
L_nb:
  s_cmp_lg_u32 s41, 1
  s_cbranch_scc1 L_nsA
  s_mov_b32 s45, 1
  s_atomic_add s45, s[46:47], 0x0 glc
L_nsA:
  s_nop 0
  v_mfma_f32_16x16x16_bf16 v[32:35], v[80:81], v[56:57], v[32:35]
  v_mfma_f32_16x16x16_bf16 v[36:39], v[82:83], v[56:57], v[36:39]
  v_mfma_f32_16x16x16_bf16 v[32:35], v[84:85], v[58:59], v[32:35]
  v_mfma_f32_16x16x16_bf16 v[36:39], v[86:87], v[58:59], v[36:39]
  v_mfma_f32_16x16x16_bf16 v[32:35], v[88:89], v[60:61], v[32:35]
  v_mfma_f32_16x16x16_bf16 v[36:39], v[90:91], v[60:61], v[36:39]
  v_mfma_f32_16x16x16_bf16 v[32:35], v[92:93], v[62:63], v[32:35]
  v_mfma_f32_16x16x16_bf16 v[36:39], v[94:95], v[62:63], v[36:39]
  s_waitcnt vmcnt(4)
  buffer_load_dwordx4 v[64:67], v1, s[32:35], s40 offen offset:0 nt
  buffer_load_dwordx4 v[68:71], v1, s[32:35], s40 offen offset:1024 nt
  buffer_load_dwordx4 v[72:75], v1, s[32:35], s40 offen offset:2048 nt
  buffer_load_dwordx4 v[76:79], v1, s[32:35], s40 offen offset:3072 nt
  s_waitcnt vmcnt(8)
  v_dot2_f32_bf16 v40, v96, v4, 0
  v_dot2_f32_bf16 v41, v100, v4, 0
  v_dot2_f32_bf16 v42, v104, v4, 0
  v_dot2_f32_bf16 v43, v108, v4, 0
  v_dot2c_f32_bf16 v40, v97, v5
  v_dot2c_f32_bf16 v41, v101, v5
  v_dot2c_f32_bf16 v42, v105, v5
  v_dot2c_f32_bf16 v43, v109, v5
  v_dot2c_f32_bf16 v40, v98, v6
  v_dot2c_f32_bf16 v41, v102, v6
  v_dot2c_f32_bf16 v42, v106, v6
  v_dot2c_f32_bf16 v43, v110, v6
  v_dot2c_f32_bf16 v40, v99, v7
  v_dot2c_f32_bf16 v41, v103, v7
  v_dot2c_f32_bf16 v42, v107, v7
  v_dot2c_f32_bf16 v43, v111, v7
  v_add_f32_dpp v44, v40, v40 row_ror:8 row_mask:0xf bank_mask:0x3
  v_add_f32_dpp v45, v41, v41 row_ror:8 row_mask:0xf bank_mask:0x3
  v_add_f32_dpp v44, v42, v42 row_ror:8 row_mask:0xf bank_mask:0xc
  v_add_f32_dpp v45, v43, v43 row_ror:8 row_mask:0xf bank_mask:0xc
  s_nop 0
  v_add_f32_dpp v52, v44, v44 row_shl:4 row_mask:0xf bank_mask:0x5
  v_add_f32_dpp v52, v45, v45 row_shr:4 row_mask:0xf bank_mask:0xa
  s_nop 1
  v_add_f32_dpp v52, v52, v52 quad_perm:[1,0,3,2] row_mask:0xf bank_mask:0xf
  s_nop 1
  v_add_f32_dpp v52, v52, v52 quad_perm:[2,3,0,1] row_mask:0xf bank_mask:0xf
  v_cvt_pk_bf16_f32 v52, v52, v52
  v_and_b32 v52, s53, v52
  v_mul_f32 v52, s52, v52
  v_cvt_pk_bf16_f32 v52, v52, v52
  v_and_b32 v52, s53, v52
  v_mul_f32 v40, s43, v52
  v_mul_f32 v18, s43, v52
  v_mul_f32 v19, s43, v52
  s_nop 1
  v_permlane16_swap_b32 v18, v19
  v_max_f32 v18, v18, v19
  v_mov_b32 v19, v18
  s_nop 1
  v_permlane32_swap_b32 v18, v19
  v_max3_f32 v20, v18, v19, v16
  v_sub_f32 v22, v16, v20
  v_sub_f32 v24, v40, v20
  v_exp_f32 v22, v22
  v_exp_f32 v24, v24
  v_mov_b32 v16, v20
  v_fma_f32 v17, v17, v22, v24
  v_pk_mul_f32 v[32:33], v[32:33], v[22:23] op_sel_hi:[1,0]
  v_pk_mul_f32 v[34:35], v[34:35], v[22:23] op_sel_hi:[1,0]
  v_pk_mul_f32 v[36:37], v[36:37], v[22:23] op_sel_hi:[1,0]
  v_pk_mul_f32 v[38:39], v[38:39], v[22:23] op_sel_hi:[1,0]
  v_cvt_pk_bf16_f32 v18, v24, v24
  v_and_b32 v56, v18, v8
  v_and_b32 v57, v18, v9
  v_and_b32 v58, v18, v10
  v_and_b32 v59, v18, v11
  v_and_b32 v60, v18, v12
  v_and_b32 v61, v18, v13
  v_and_b32 v62, v18, v14
  v_and_b32 v63, v18, v15
  s_waitcnt vmcnt(4)
  buffer_load_dwordx4 v[80:83], v1, s[36:39], s40 offen offset:0 nt
  buffer_load_dwordx4 v[84:87], v1, s[36:39], s40 offen offset:1024 nt
  buffer_load_dwordx4 v[88:91], v1, s[36:39], s40 offen offset:2048 nt
  buffer_load_dwordx4 v[92:95], v1, s[36:39], s40 offen offset:3072 nt
  s_waitcnt vmcnt(8)
  s_nop 0
  v_mfma_f32_16x16x16_bf16 v[32:35], v[112:113], v[56:57], v[32:35]
  v_mfma_f32_16x16x16_bf16 v[36:39], v[114:115], v[56:57], v[36:39]
  v_mfma_f32_16x16x16_bf16 v[32:35], v[116:117], v[58:59], v[32:35]
  v_mfma_f32_16x16x16_bf16 v[36:39], v[118:119], v[58:59], v[36:39]
  v_mfma_f32_16x16x16_bf16 v[32:35], v[120:121], v[60:61], v[32:35]
  v_mfma_f32_16x16x16_bf16 v[36:39], v[122:123], v[60:61], v[36:39]
  v_mfma_f32_16x16x16_bf16 v[32:35], v[124:125], v[62:63], v[32:35]
  v_mfma_f32_16x16x16_bf16 v[36:39], v[126:127], v[62:63], v[36:39]
  s_waitcnt vmcnt(4)
  s_add_u32 s42, s40, 16384
  buffer_load_dwordx4 v[96:99], v1, s[32:35], s42 offen offset:0 nt
  buffer_load_dwordx4 v[100:103], v1, s[32:35], s42 offen offset:1024 nt
  buffer_load_dwordx4 v[104:107], v1, s[32:35], s42 offen offset:2048 nt
  buffer_load_dwordx4 v[108:111], v1, s[32:35], s42 offen offset:3072 nt
  s_sub_u32 s41, s41, 1
  s_cmp_lg_u32 s41, 0
  s_cbranch_scc1 L_loopA
  s_waitcnt vmcnt(8)
  v_dot2_f32_bf16 v40, v64, v4, 0
  v_dot2_f32_bf16 v41, v68, v4, 0
  v_dot2_f32_bf16 v42, v72, v4, 0
  v_dot2_f32_bf16 v43, v76, v4, 0
  v_dot2c_f32_bf16 v40, v65, v5
  v_dot2c_f32_bf16 v41, v69, v5
  v_dot2c_f32_bf16 v42, v73, v5
  v_dot2c_f32_bf16 v43, v77, v5
  v_dot2c_f32_bf16 v40, v66, v6
  v_dot2c_f32_bf16 v41, v70, v6
  v_dot2c_f32_bf16 v42, v74, v6
  v_dot2c_f32_bf16 v43, v78, v6
  v_dot2c_f32_bf16 v40, v67, v7
  v_dot2c_f32_bf16 v41, v71, v7
  v_dot2c_f32_bf16 v42, v75, v7
  v_dot2c_f32_bf16 v43, v79, v7
  v_add_f32_dpp v44, v40, v40 row_ror:8 row_mask:0xf bank_mask:0x3
  v_add_f32_dpp v45, v41, v41 row_ror:8 row_mask:0xf bank_mask:0x3
  v_add_f32_dpp v44, v42, v42 row_ror:8 row_mask:0xf bank_mask:0xc
  v_add_f32_dpp v45, v43, v43 row_ror:8 row_mask:0xf bank_mask:0xc
  s_nop 0
  v_add_f32_dpp v52, v44, v44 row_shl:4 row_mask:0xf bank_mask:0x5
  v_add_f32_dpp v52, v45, v45 row_shr:4 row_mask:0xf bank_mask:0xa
  s_nop 1
  v_add_f32_dpp v52, v52, v52 quad_perm:[1,0,3,2] row_mask:0xf bank_mask:0xf
  s_nop 1
  v_add_f32_dpp v52, v52, v52 quad_perm:[2,3,0,1] row_mask:0xf bank_mask:0xf
  v_cvt_pk_bf16_f32 v52, v52, v52
  v_and_b32 v52, s53, v52
  v_mul_f32 v52, s52, v52
  v_cvt_pk_bf16_f32 v52, v52, v52
  v_and_b32 v52, s53, v52
  v_mul_f32 v40, s43, v52
  v_mul_f32 v18, s43, v52
  v_mul_f32 v19, s43, v52
  s_nop 1
  v_permlane16_swap_b32 v18, v19
  v_max_f32 v18, v18, v19
  v_mov_b32 v19, v18
  s_nop 1
  v_permlane32_swap_b32 v18, v19
  v_max3_f32 v20, v18, v19, v16
  v_sub_f32 v22, v16, v20
  v_sub_f32 v24, v40, v20
  v_exp_f32 v22, v22
  v_exp_f32 v24, v24
  v_mov_b32 v16, v20
  v_fma_f32 v17, v17, v22, v24
  v_pk_mul_f32 v[32:33], v[32:33], v[22:23] op_sel_hi:[1,0]
  v_pk_mul_f32 v[34:35], v[34:35], v[22:23] op_sel_hi:[1,0]
  v_pk_mul_f32 v[36:37], v[36:37], v[22:23] op_sel_hi:[1,0]
  v_pk_mul_f32 v[38:39], v[38:39], v[22:23] op_sel_hi:[1,0]
  v_cvt_pk_bf16_f32 v18, v24, v24
  v_and_b32 v56, v18, v8
  v_and_b32 v57, v18, v9
  v_and_b32 v58, v18, v10
  v_and_b32 v59, v18, v11
  v_and_b32 v60, v18, v12
  v_and_b32 v61, v18, v13
  v_and_b32 v62, v18, v14
  v_and_b32 v63, v18, v15
  s_waitcnt vmcnt(4)
  s_add_u32 s42, s40, 16384
  buffer_load_dwordx4 v[112:115], v1, s[36:39], s42 offen offset:0 nt
  buffer_load_dwordx4 v[116:119], v1, s[36:39], s42 offen offset:1024 nt
  buffer_load_dwordx4 v[120:123], v1, s[36:39], s42 offen offset:2048 nt
  buffer_load_dwordx4 v[124:127], v1, s[36:39], s42 offen offset:3072 nt
  s_mov_b64 s[32:33], s[16:17]
  s_mov_b64 s[36:37], s[18:19]
  s_mov_b32 s34, 67108864
  s_mov_b32 s38, 67108864
  v_lshlrev_b32 v1, 4, v2
  s_waitcnt vmcnt(8)
  s_waitcnt lgkmcnt(0)
  s_add_u32 s50, s45, 1
  s_cmp_lt_u32 s50, 256
  s_cbranch_scc1 L_moreA1
  s_mov_b32 s34, 0
  s_mov_b32 s38, 0
  s_branch L_nsA1
L_moreA1:
  s_lshl_b32 s48, s50, 12
  s_add_u32 s48, s48, s44
  s_mov_b32 s45, 1
  s_atomic_add s45, s[46:47], 0x0 glc
L_nsA1:
  s_nop 0
  v_mfma_f32_16x16x16_bf16 v[32:35], v[80:81], v[56:57], v[32:35]
  v_mfma_f32_16x16x16_bf16 v[36:39], v[82:83], v[56:57], v[36:39]
  v_mfma_f32_16x16x16_bf16 v[32:35], v[84:85], v[58:59], v[32:35]
  v_mfma_f32_16x16x16_bf16 v[36:39], v[86:87], v[58:59], v[36:39]
  v_mfma_f32_16x16x16_bf16 v[32:35], v[88:89], v[60:61], v[32:35]
  v_mfma_f32_16x16x16_bf16 v[36:39], v[90:91], v[60:61], v[36:39]
  v_mfma_f32_16x16x16_bf16 v[32:35], v[92:93], v[62:63], v[32:35]
  v_mfma_f32_16x16x16_bf16 v[36:39], v[94:95], v[62:63], v[36:39]
  s_waitcnt vmcnt(4)
  buffer_load_dwordx4 v[64:67], v1, s[32:35], s48 offen offset:0 nt
  buffer_load_dwordx4 v[68:71], v1, s[32:35], s48 offen offset:1024 nt
  buffer_load_dwordx4 v[72:75], v1, s[32:35], s48 offen offset:2048 nt
  buffer_load_dwordx4 v[76:79], v1, s[32:35], s48 offen offset:3072 nt
  s_waitcnt vmcnt(8)
  v_dot2_f32_bf16 v40, v96, v4, 0
  v_dot2_f32_bf16 v41, v100, v4, 0
  v_dot2_f32_bf16 v42, v104, v4, 0
  v_dot2_f32_bf16 v43, v108, v4, 0
  v_dot2c_f32_bf16 v40, v97, v5
  v_dot2c_f32_bf16 v41, v101, v5
  v_dot2c_f32_bf16 v42, v105, v5
  v_dot2c_f32_bf16 v43, v109, v5
  v_dot2c_f32_bf16 v40, v98, v6
  v_dot2c_f32_bf16 v41, v102, v6
  v_dot2c_f32_bf16 v42, v106, v6
  v_dot2c_f32_bf16 v43, v110, v6
  v_dot2c_f32_bf16 v40, v99, v7
  v_dot2c_f32_bf16 v41, v103, v7
  v_dot2c_f32_bf16 v42, v107, v7
  v_dot2c_f32_bf16 v43, v111, v7
  v_add_f32_dpp v44, v40, v40 row_ror:8 row_mask:0xf bank_mask:0x3
  v_add_f32_dpp v45, v41, v41 row_ror:8 row_mask:0xf bank_mask:0x3
  v_add_f32_dpp v44, v42, v42 row_ror:8 row_mask:0xf bank_mask:0xc
  v_add_f32_dpp v45, v43, v43 row_ror:8 row_mask:0xf bank_mask:0xc
  s_nop 0
  v_add_f32_dpp v52, v44, v44 row_shl:4 row_mask:0xf bank_mask:0x5
  v_add_f32_dpp v52, v45, v45 row_shr:4 row_mask:0xf bank_mask:0xa
  s_nop 1
  v_add_f32_dpp v52, v52, v52 quad_perm:[1,0,3,2] row_mask:0xf bank_mask:0xf
  s_nop 1
  v_add_f32_dpp v52, v52, v52 quad_perm:[2,3,0,1] row_mask:0xf bank_mask:0xf
  v_cvt_pk_bf16_f32 v52, v52, v52
  v_and_b32 v52, s53, v52
  v_mul_f32 v52, s52, v52
  v_cvt_pk_bf16_f32 v52, v52, v52
  v_and_b32 v52, s53, v52
  v_mul_f32 v40, s43, v52
  v_mul_f32 v18, s43, v52
  v_mul_f32 v19, s43, v52
  s_nop 1
  v_permlane16_swap_b32 v18, v19
  v_max_f32 v18, v18, v19
  v_mov_b32 v19, v18
  s_nop 1
  v_permlane32_swap_b32 v18, v19
  v_max3_f32 v20, v18, v19, v16
  v_sub_f32 v22, v16, v20
  v_sub_f32 v24, v40, v20
  v_exp_f32 v22, v22
  v_exp_f32 v24, v24
  v_mov_b32 v16, v20
  v_fma_f32 v17, v17, v22, v24
  v_pk_mul_f32 v[32:33], v[32:33], v[22:23] op_sel_hi:[1,0]
  v_pk_mul_f32 v[34:35], v[34:35], v[22:23] op_sel_hi:[1,0]
  v_pk_mul_f32 v[36:37], v[36:37], v[22:23] op_sel_hi:[1,0]
  v_pk_mul_f32 v[38:39], v[38:39], v[22:23] op_sel_hi:[1,0]
  v_cvt_pk_bf16_f32 v18, v24, v24
  v_and_b32 v56, v18, v8
  v_and_b32 v57, v18, v9
  v_and_b32 v58, v18, v10
  v_and_b32 v59, v18, v11
  v_and_b32 v60, v18, v12
  v_and_b32 v61, v18, v13
  v_and_b32 v62, v18, v14
  v_and_b32 v63, v18, v15
  s_waitcnt vmcnt(4)
  buffer_load_dwordx4 v[80:83], v1, s[36:39], s48 offen offset:0 nt
  buffer_load_dwordx4 v[84:87], v1, s[36:39], s48 offen offset:1024 nt
  buffer_load_dwordx4 v[88:91], v1, s[36:39], s48 offen offset:2048 nt
  buffer_load_dwordx4 v[92:95], v1, s[36:39], s48 offen offset:3072 nt
  s_waitcnt vmcnt(8)
  s_waitcnt lgkmcnt(0)
  s_add_u32 s51, s45, 1
  s_cmp_lt_u32 s51, 256
  s_cbranch_scc1 L_moreA3
  s_mov_b32 s34, 0
  s_mov_b32 s38, 0
  s_branch L_nsA3
L_moreA3:
  s_lshl_b32 s49, s51, 12
  s_add_u32 s49, s49, s44
  s_mov_b32 s45, 1
  s_atomic_add s45, s[46:47], 0x0 glc
L_nsA3:
  s_nop 0
  v_mfma_f32_16x16x16_bf16 v[32:35], v[112:113], v[56:57], v[32:35]
  v_mfma_f32_16x16x16_bf16 v[36:39], v[114:115], v[56:57], v[36:39]
  v_mfma_f32_16x16x16_bf16 v[32:35], v[116:117], v[58:59], v[32:35]
  v_mfma_f32_16x16x16_bf16 v[36:39], v[118:119], v[58:59], v[36:39]
  v_mfma_f32_16x16x16_bf16 v[32:35], v[120:121], v[60:61], v[32:35]
  v_mfma_f32_16x16x16_bf16 v[36:39], v[122:123], v[60:61], v[36:39]
  v_mfma_f32_16x16x16_bf16 v[32:35], v[124:125], v[62:63], v[32:35]
  v_mfma_f32_16x16x16_bf16 v[36:39], v[126:127], v[62:63], v[36:39]
  s_waitcnt vmcnt(4)
  buffer_load_dwordx4 v[96:99], v1, s[32:35], s49 offen offset:0 nt
  buffer_load_dwordx4 v[100:103], v1, s[32:35], s49 offen offset:1024 nt
  buffer_load_dwordx4 v[104:107], v1, s[32:35], s49 offen offset:2048 nt
  buffer_load_dwordx4 v[108:111], v1, s[32:35], s49 offen offset:3072 nt
  v_max_f32_dpp v18, v16, v16 row_ror:4 row_mask:0xf bank_mask:0xf
  v_or_b32 v152, v8, v10
  v_or_b32 v153, v9, v11
  v_max_f32_dpp v18, v18, v18 row_ror:8 row_mask:0xf bank_mask:0xf
  v_sub_f32 v22, v16, v18
  v_exp_f32 v22, v22
  ds_write_b32 v21, v18 offset:5120
  v_mul_f32 v17, v17, v22
  v_pk_mul_f32 v[32:33], v[32:33], v[22:23] op_sel_hi:[1,0]
  v_pk_mul_f32 v[34:35], v[34:35], v[22:23] op_sel_hi:[1,0]
  v_pk_mul_f32 v[36:37], v[36:37], v[22:23] op_sel_hi:[1,0]
  v_pk_mul_f32 v[38:39], v[38:39], v[22:23] op_sel_hi:[1,0]
  v_add_f32_dpp v17, v17, v17 row_ror:4 row_mask:0xf bank_mask:0xf
  v_add_f32_dpp v44, v32, v32 row_ror:8 row_mask:0xf bank_mask:0x3
  v_add_f32_dpp v45, v33, v33 row_ror:8 row_mask:0xf bank_mask:0x3
  v_add_f32_dpp v44, v34, v34 row_ror:8 row_mask:0xf bank_mask:0xc
  v_add_f32_dpp v45, v35, v35 row_ror:8 row_mask:0xf bank_mask:0xc
  s_nop 0
  v_add_f32_dpp v52, v44, v44 row_shl:4 row_mask:0xf bank_mask:0x5
  v_add_f32_dpp v52, v45, v45 row_shr:4 row_mask:0xf bank_mask:0xa
  v_add_f32_dpp v17, v17, v17 row_ror:8 row_mask:0xf bank_mask:0xf
  ds_write_b32 v28, v52 offset:3072
  v_mov_b32 v19, v17
  v_add_f32_dpp v46, v36, v36 row_ror:8 row_mask:0xf bank_mask:0x3
  v_add_f32_dpp v47, v37, v37 row_ror:8 row_mask:0xf bank_mask:0x3
  v_add_f32_dpp v46, v38, v38 row_ror:8 row_mask:0xf bank_mask:0xc
  v_add_f32_dpp v47, v39, v39 row_ror:8 row_mask:0xf bank_mask:0xc
  s_nop 0
  v_add_f32_dpp v53, v46, v46 row_shl:4 row_mask:0xf bank_mask:0x5
  v_add_f32_dpp v53, v47, v47 row_shr:4 row_mask:0xf bank_mask:0xa
  v_permlane16_swap_b32 v17, v19
  ds_write_b32 v28, v53 offset:3088
  v_add_f32 v17, v17, v19
  v_mov_b32 v19, v17
  v_or3_b32 v152, v152, v12, v14
  v_or3_b32 v153, v153, v13, v15
  v_permlane32_swap_b32 v17, v19
  v_add_f32 v17, v17, v19
  ds_write_b32 v21, v17 offset:5136
  v_lshrrev_b32 v18, 1, v3
  v_mov_b32 v154, 0xff7fffff
  v_mov_b32 v155, 0
  v_mov_b32 v144, 0
  v_mov_b32 v145, 0
  v_mov_b32 v146, 0
  v_mov_b32 v147, 0
  v_mov_b32 v148, 0
  v_mov_b32 v149, 0
  v_mov_b32 v150, 0
  v_mov_b32 v151, 0
  s_waitcnt lgkmcnt(0)
  s_barrier
  ds_read_b128 v[128:131], v18 offset:2048
  ds_read_b128 v[132:135], v18 offset:2304
  ds_read_b128 v[136:139], v18 offset:2560
  ds_read_b128 v[140:143], v18 offset:2816
  s_waitcnt lgkmcnt(0)
  s_cmp_lt_u32 s50, 256
  s_cbranch_scc0 L_finB
L_loopB:
  s_waitcnt vmcnt(8)
  v_dot2_f32_bf16 v156, v64, v128, 0
  v_dot2_f32_bf16 v157, v64, v132, 0
  v_dot2_f32_bf16 v158, v64, v136, 0
  v_dot2_f32_bf16 v159, v64, v140, 0
  v_dot2c_f32_bf16 v156, v65, v129
  v_dot2c_f32_bf16 v157, v65, v133
  v_dot2c_f32_bf16 v158, v65, v137
  v_dot2c_f32_bf16 v159, v65, v141
  v_dot2c_f32_bf16 v156, v66, v130
  v_dot2c_f32_bf16 v157, v66, v134
  v_dot2c_f32_bf16 v158, v66, v138
  v_dot2c_f32_bf16 v159, v66, v142
  v_dot2c_f32_bf16 v156, v67, v131
  v_dot2c_f32_bf16 v157, v67, v135
  v_dot2c_f32_bf16 v158, v67, v139
  v_dot2c_f32_bf16 v159, v67, v143
  v_dot2_f32_bf16 v160, v68, v128, 0
  v_dot2_f32_bf16 v161, v68, v132, 0
  v_dot2_f32_bf16 v162, v68, v136, 0
  v_dot2_f32_bf16 v163, v68, v140, 0
  v_dot2c_f32_bf16 v160, v69, v129
  v_dot2c_f32_bf16 v161, v69, v133
  v_dot2c_f32_bf16 v162, v69, v137
  v_dot2c_f32_bf16 v163, v69, v141
  v_dot2c_f32_bf16 v160, v70, v130
  v_dot2c_f32_bf16 v161, v70, v134
  v_dot2c_f32_bf16 v162, v70, v138
  v_dot2c_f32_bf16 v163, v70, v142
  v_dot2c_f32_bf16 v160, v71, v131
  v_dot2c_f32_bf16 v161, v71, v135
  v_dot2c_f32_bf16 v162, v71, v139
  v_dot2c_f32_bf16 v163, v71, v143
  v_dot2_f32_bf16 v164, v72, v128, 0
  v_dot2_f32_bf16 v165, v72, v132, 0
  v_dot2_f32_bf16 v166, v72, v136, 0
  v_dot2_f32_bf16 v167, v72, v140, 0
  v_dot2c_f32_bf16 v164, v73, v129
  v_dot2c_f32_bf16 v165, v73, v133
  v_dot2c_f32_bf16 v166, v73, v137
  v_dot2c_f32_bf16 v167, v73, v141
  v_dot2c_f32_bf16 v164, v74, v130
  v_dot2c_f32_bf16 v165, v74, v134
  v_dot2c_f32_bf16 v166, v74, v138
  v_dot2c_f32_bf16 v167, v74, v142
  v_dot2c_f32_bf16 v164, v75, v131
  v_dot2c_f32_bf16 v165, v75, v135
  v_dot2c_f32_bf16 v166, v75, v139
  v_dot2c_f32_bf16 v167, v75, v143
  v_dot2_f32_bf16 v168, v76, v128, 0
  v_dot2_f32_bf16 v169, v76, v132, 0
  v_dot2_f32_bf16 v170, v76, v136, 0
  v_dot2_f32_bf16 v171, v76, v140, 0
  v_dot2c_f32_bf16 v168, v77, v129
  v_dot2c_f32_bf16 v169, v77, v133
  v_dot2c_f32_bf16 v170, v77, v137
  v_dot2c_f32_bf16 v171, v77, v141
  v_dot2c_f32_bf16 v168, v78, v130
  v_dot2c_f32_bf16 v169, v78, v134
  v_dot2c_f32_bf16 v170, v78, v138
  v_dot2c_f32_bf16 v171, v78, v142
  v_dot2c_f32_bf16 v168, v79, v131
  v_dot2c_f32_bf16 v169, v79, v135
  v_dot2c_f32_bf16 v170, v79, v139
  v_dot2c_f32_bf16 v171, v79, v143
  v_add_f32_dpp v44, v156, v156 row_ror:8 row_mask:0xf bank_mask:0x3
  v_add_f32_dpp v45, v157, v157 row_ror:8 row_mask:0xf bank_mask:0x3
  v_add_f32_dpp v44, v158, v158 row_ror:8 row_mask:0xf bank_mask:0xc
  v_add_f32_dpp v45, v159, v159 row_ror:8 row_mask:0xf bank_mask:0xc
  v_add_f32_dpp v46, v160, v160 row_ror:8 row_mask:0xf bank_mask:0x3
  v_add_f32_dpp v47, v161, v161 row_ror:8 row_mask:0xf bank_mask:0x3
  v_add_f32_dpp v46, v162, v162 row_ror:8 row_mask:0xf bank_mask:0xc
  v_add_f32_dpp v47, v163, v163 row_ror:8 row_mask:0xf bank_mask:0xc
  v_add_f32_dpp v48, v164, v164 row_ror:8 row_mask:0xf bank_mask:0x3
  v_add_f32_dpp v49, v165, v165 row_ror:8 row_mask:0xf bank_mask:0x3
  v_add_f32_dpp v48, v166, v166 row_ror:8 row_mask:0xf bank_mask:0xc
  v_add_f32_dpp v49, v167, v167 row_ror:8 row_mask:0xf bank_mask:0xc
  v_add_f32_dpp v50, v168, v168 row_ror:8 row_mask:0xf bank_mask:0x3
  v_add_f32_dpp v51, v169, v169 row_ror:8 row_mask:0xf bank_mask:0x3
  v_add_f32_dpp v50, v170, v170 row_ror:8 row_mask:0xf bank_mask:0xc
  v_add_f32_dpp v51, v171, v171 row_ror:8 row_mask:0xf bank_mask:0xc
  v_add_f32_dpp v52, v44, v44 row_shl:4 row_mask:0xf bank_mask:0x5
  v_add_f32_dpp v53, v46, v46 row_shl:4 row_mask:0xf bank_mask:0x5
  v_add_f32_dpp v54, v48, v48 row_shl:4 row_mask:0xf bank_mask:0x5
  v_add_f32_dpp v55, v50, v50 row_shl:4 row_mask:0xf bank_mask:0x5
  v_add_f32_dpp v52, v45, v45 row_shr:4 row_mask:0xf bank_mask:0xa
  v_add_f32_dpp v53, v47, v47 row_shr:4 row_mask:0xf bank_mask:0xa
  v_add_f32_dpp v54, v49, v49 row_shr:4 row_mask:0xf bank_mask:0xa
  v_add_f32_dpp v55, v51, v51 row_shr:4 row_mask:0xf bank_mask:0xa
  v_add_f32_dpp v52, v52, v52 quad_perm:[1,0,3,2] row_mask:0xf bank_mask:0xf
  v_add_f32_dpp v53, v53, v53 quad_perm:[1,0,3,2] row_mask:0xf bank_mask:0xf
  v_add_f32_dpp v54, v54, v54 quad_perm:[1,0,3,2] row_mask:0xf bank_mask:0xf
  v_add_f32_dpp v55, v55, v55 quad_perm:[1,0,3,2] row_mask:0xf bank_mask:0xf
  v_add_f32_dpp v52, v52, v52 quad_perm:[2,3,0,1] row_mask:0xf bank_mask:0xf
  v_add_f32_dpp v53, v53, v53 quad_perm:[2,3,0,1] row_mask:0xf bank_mask:0xf
  v_add_f32_dpp v54, v54, v54 quad_perm:[2,3,0,1] row_mask:0xf bank_mask:0xf
  v_add_f32_dpp v55, v55, v55 quad_perm:[2,3,0,1] row_mask:0xf bank_mask:0xf
  v_cvt_pk_bf16_f32 v52, v52, v52
  v_cvt_pk_bf16_f32 v53, v53, v53
  v_cvt_pk_bf16_f32 v54, v54, v54
  v_cvt_pk_bf16_f32 v55, v55, v55
  v_and_b32 v52, s53, v52
  v_and_b32 v53, s53, v53
  v_and_b32 v54, s53, v54
  v_and_b32 v55, s53, v55
  v_mul_f32 v52, s52, v52
  v_mul_f32 v53, s52, v53
  v_mul_f32 v54, s52, v54
  v_mul_f32 v55, s52, v55
  v_cvt_pk_bf16_f32 v52, v52, v52
  v_cvt_pk_bf16_f32 v53, v53, v53
  v_cvt_pk_bf16_f32 v54, v54, v54
  v_cvt_pk_bf16_f32 v55, v55, v55
  v_and_b32 v52, s53, v52
  v_and_b32 v53, s53, v53
  v_and_b32 v54, s53, v54
  v_and_b32 v55, s53, v55
  v_mul_f32 v40, s43, v52
  v_mul_f32 v41, s43, v53
  v_mul_f32 v42, s43, v54
  v_mul_f32 v43, s43, v55
  v_max3_f32 v18, v40, v41, v42
  v_max_f32 v18, v18, v43
  v_mov_b32 v19, v18
  s_nop 1
  v_permlane16_swap_b32 v18, v19
  v_max_f32 v18, v18, v19
  v_mov_b32 v19, v18
  s_nop 1
  v_permlane32_swap_b32 v18, v19
  v_max3_f32 v20, v18, v19, v154
  v_sub_f32 v22, v154, v20
  v_sub_f32 v24, v40, v20
  v_sub_f32 v25, v41, v20
  v_sub_f32 v26, v42, v20
  v_sub_f32 v27, v43, v20
  v_exp_f32 v22, v22
  v_exp_f32 v24, v24
  v_exp_f32 v25, v25
  v_exp_f32 v26, v26
  v_exp_f32 v27, v27
  v_mov_b32 v154, v20
  v_fma_f32 v155, v155, v22, v24
  v_pk_mul_f32 v[144:145], v[144:145], v[22:23] op_sel_hi:[1,0]
  v_pk_mul_f32 v[146:147], v[146:147], v[22:23] op_sel_hi:[1,0]
  v_pk_mul_f32 v[148:149], v[148:149], v[22:23] op_sel_hi:[1,0]
  v_pk_mul_f32 v[150:151], v[150:151], v[22:23] op_sel_hi:[1,0]
  v_add_f32 v155, v155, v25
  v_add_f32 v155, v155, v26
  v_add_f32 v155, v155, v27
  v_cvt_pk_bf16_f32 v40, v24, v24
  v_cvt_pk_bf16_f32 v41, v25, v25
  v_cvt_pk_bf16_f32 v42, v26, v26
  v_cvt_pk_bf16_f32 v43, v27, v27
  v_and_b32 v56, v40, v152
  v_and_b32 v57, v40, v153
  v_and_b32 v58, v41, v152
  v_and_b32 v59, v41, v153
  v_and_b32 v60, v42, v152
  v_and_b32 v61, v42, v153
  v_and_b32 v62, v43, v152
  v_and_b32 v63, v43, v153
  s_waitcnt vmcnt(4)
  buffer_load_dwordx4 v[112:115], v1, s[36:39], s49 offen offset:0 nt
  buffer_load_dwordx4 v[116:119], v1, s[36:39], s49 offen offset:1024 nt
  buffer_load_dwordx4 v[120:123], v1, s[36:39], s49 offen offset:2048 nt
  buffer_load_dwordx4 v[124:127], v1, s[36:39], s49 offen offset:3072 nt
  s_waitcnt vmcnt(8)
  s_waitcnt lgkmcnt(0)
  s_add_u32 s50, s45, 1
  s_cmp_lt_u32 s50, 256
  s_cbranch_scc1 L_moreB1
  s_mov_b32 s34, 0
  s_mov_b32 s38, 0
  s_branch L_nsB1
L_moreB1:
  s_lshl_b32 s48, s50, 12
  s_add_u32 s48, s48, s44
  s_mov_b32 s45, 1
  s_atomic_add s45, s[46:47], 0x0 glc
L_nsB1:
  s_nop 0
  v_mfma_f32_16x16x16_bf16 v[144:147], v[80:81], v[56:57], v[144:147]
  v_mfma_f32_16x16x16_bf16 v[148:151], v[82:83], v[56:57], v[148:151]
  v_mfma_f32_16x16x16_bf16 v[144:147], v[84:85], v[58:59], v[144:147]
  v_mfma_f32_16x16x16_bf16 v[148:151], v[86:87], v[58:59], v[148:151]
  v_mfma_f32_16x16x16_bf16 v[144:147], v[88:89], v[60:61], v[144:147]
  v_mfma_f32_16x16x16_bf16 v[148:151], v[90:91], v[60:61], v[148:151]
  v_mfma_f32_16x16x16_bf16 v[144:147], v[92:93], v[62:63], v[144:147]
  v_mfma_f32_16x16x16_bf16 v[148:151], v[94:95], v[62:63], v[148:151]
  s_waitcnt vmcnt(4)
  buffer_load_dwordx4 v[64:67], v1, s[32:35], s48 offen offset:0 nt
  buffer_load_dwordx4 v[68:71], v1, s[32:35], s48 offen offset:1024 nt
  buffer_load_dwordx4 v[72:75], v1, s[32:35], s48 offen offset:2048 nt
  buffer_load_dwordx4 v[76:79], v1, s[32:35], s48 offen offset:3072 nt
  s_cmp_lt_u32 s51, 256
  s_cbranch_scc0 L_finB
  s_waitcnt vmcnt(8)
  v_dot2_f32_bf16 v156, v96, v128, 0
  v_dot2_f32_bf16 v157, v96, v132, 0
  v_dot2_f32_bf16 v158, v96, v136, 0
  v_dot2_f32_bf16 v159, v96, v140, 0
  v_dot2c_f32_bf16 v156, v97, v129
  v_dot2c_f32_bf16 v157, v97, v133
  v_dot2c_f32_bf16 v158, v97, v137
  v_dot2c_f32_bf16 v159, v97, v141
  v_dot2c_f32_bf16 v156, v98, v130
  v_dot2c_f32_bf16 v157, v98, v134
  v_dot2c_f32_bf16 v158, v98, v138
  v_dot2c_f32_bf16 v159, v98, v142
  v_dot2c_f32_bf16 v156, v99, v131
  v_dot2c_f32_bf16 v157, v99, v135
  v_dot2c_f32_bf16 v158, v99, v139
  v_dot2c_f32_bf16 v159, v99, v143
  v_dot2_f32_bf16 v160, v100, v128, 0
  v_dot2_f32_bf16 v161, v100, v132, 0
  v_dot2_f32_bf16 v162, v100, v136, 0
  v_dot2_f32_bf16 v163, v100, v140, 0
  v_dot2c_f32_bf16 v160, v101, v129
  v_dot2c_f32_bf16 v161, v101, v133
  v_dot2c_f32_bf16 v162, v101, v137
  v_dot2c_f32_bf16 v163, v101, v141
  v_dot2c_f32_bf16 v160, v102, v130
  v_dot2c_f32_bf16 v161, v102, v134
  v_dot2c_f32_bf16 v162, v102, v138
  v_dot2c_f32_bf16 v163, v102, v142
  v_dot2c_f32_bf16 v160, v103, v131
  v_dot2c_f32_bf16 v161, v103, v135
  v_dot2c_f32_bf16 v162, v103, v139
  v_dot2c_f32_bf16 v163, v103, v143
  v_dot2_f32_bf16 v164, v104, v128, 0
  v_dot2_f32_bf16 v165, v104, v132, 0
  v_dot2_f32_bf16 v166, v104, v136, 0
  v_dot2_f32_bf16 v167, v104, v140, 0
  v_dot2c_f32_bf16 v164, v105, v129
  v_dot2c_f32_bf16 v165, v105, v133
  v_dot2c_f32_bf16 v166, v105, v137
  v_dot2c_f32_bf16 v167, v105, v141
  v_dot2c_f32_bf16 v164, v106, v130
  v_dot2c_f32_bf16 v165, v106, v134
  v_dot2c_f32_bf16 v166, v106, v138
  v_dot2c_f32_bf16 v167, v106, v142
  v_dot2c_f32_bf16 v164, v107, v131
  v_dot2c_f32_bf16 v165, v107, v135
  v_dot2c_f32_bf16 v166, v107, v139
  v_dot2c_f32_bf16 v167, v107, v143
  v_dot2_f32_bf16 v168, v108, v128, 0
  v_dot2_f32_bf16 v169, v108, v132, 0
  v_dot2_f32_bf16 v170, v108, v136, 0
  v_dot2_f32_bf16 v171, v108, v140, 0
  v_dot2c_f32_bf16 v168, v109, v129
  v_dot2c_f32_bf16 v169, v109, v133
  v_dot2c_f32_bf16 v170, v109, v137
  v_dot2c_f32_bf16 v171, v109, v141
  v_dot2c_f32_bf16 v168, v110, v130
  v_dot2c_f32_bf16 v169, v110, v134
  v_dot2c_f32_bf16 v170, v110, v138
  v_dot2c_f32_bf16 v171, v110, v142
  v_dot2c_f32_bf16 v168, v111, v131
  v_dot2c_f32_bf16 v169, v111, v135
  v_dot2c_f32_bf16 v170, v111, v139
  v_dot2c_f32_bf16 v171, v111, v143
  v_add_f32_dpp v44, v156, v156 row_ror:8 row_mask:0xf bank_mask:0x3
  v_add_f32_dpp v45, v157, v157 row_ror:8 row_mask:0xf bank_mask:0x3
  v_add_f32_dpp v44, v158, v158 row_ror:8 row_mask:0xf bank_mask:0xc
  v_add_f32_dpp v45, v159, v159 row_ror:8 row_mask:0xf bank_mask:0xc
  v_add_f32_dpp v46, v160, v160 row_ror:8 row_mask:0xf bank_mask:0x3
  v_add_f32_dpp v47, v161, v161 row_ror:8 row_mask:0xf bank_mask:0x3
  v_add_f32_dpp v46, v162, v162 row_ror:8 row_mask:0xf bank_mask:0xc
  v_add_f32_dpp v47, v163, v163 row_ror:8 row_mask:0xf bank_mask:0xc
  v_add_f32_dpp v48, v164, v164 row_ror:8 row_mask:0xf bank_mask:0x3
  v_add_f32_dpp v49, v165, v165 row_ror:8 row_mask:0xf bank_mask:0x3
  v_add_f32_dpp v48, v166, v166 row_ror:8 row_mask:0xf bank_mask:0xc
  v_add_f32_dpp v49, v167, v167 row_ror:8 row_mask:0xf bank_mask:0xc
  v_add_f32_dpp v50, v168, v168 row_ror:8 row_mask:0xf bank_mask:0x3
  v_add_f32_dpp v51, v169, v169 row_ror:8 row_mask:0xf bank_mask:0x3
  v_add_f32_dpp v50, v170, v170 row_ror:8 row_mask:0xf bank_mask:0xc
  v_add_f32_dpp v51, v171, v171 row_ror:8 row_mask:0xf bank_mask:0xc
  v_add_f32_dpp v52, v44, v44 row_shl:4 row_mask:0xf bank_mask:0x5
  v_add_f32_dpp v53, v46, v46 row_shl:4 row_mask:0xf bank_mask:0x5
  v_add_f32_dpp v54, v48, v48 row_shl:4 row_mask:0xf bank_mask:0x5
  v_add_f32_dpp v55, v50, v50 row_shl:4 row_mask:0xf bank_mask:0x5
  v_add_f32_dpp v52, v45, v45 row_shr:4 row_mask:0xf bank_mask:0xa
  v_add_f32_dpp v53, v47, v47 row_shr:4 row_mask:0xf bank_mask:0xa
  v_add_f32_dpp v54, v49, v49 row_shr:4 row_mask:0xf bank_mask:0xa
  v_add_f32_dpp v55, v51, v51 row_shr:4 row_mask:0xf bank_mask:0xa
  v_add_f32_dpp v52, v52, v52 quad_perm:[1,0,3,2] row_mask:0xf bank_mask:0xf
  v_add_f32_dpp v53, v53, v53 quad_perm:[1,0,3,2] row_mask:0xf bank_mask:0xf
  v_add_f32_dpp v54, v54, v54 quad_perm:[1,0,3,2] row_mask:0xf bank_mask:0xf
  v_add_f32_dpp v55, v55, v55 quad_perm:[1,0,3,2] row_mask:0xf bank_mask:0xf
  v_add_f32_dpp v52, v52, v52 quad_perm:[2,3,0,1] row_mask:0xf bank_mask:0xf
  v_add_f32_dpp v53, v53, v53 quad_perm:[2,3,0,1] row_mask:0xf bank_mask:0xf
  v_add_f32_dpp v54, v54, v54 quad_perm:[2,3,0,1] row_mask:0xf bank_mask:0xf
  v_add_f32_dpp v55, v55, v55 quad_perm:[2,3,0,1] row_mask:0xf bank_mask:0xf
  v_cvt_pk_bf16_f32 v52, v52, v52
  v_cvt_pk_bf16_f32 v53, v53, v53
  v_cvt_pk_bf16_f32 v54, v54, v54
  v_cvt_pk_bf16_f32 v55, v55, v55
  v_and_b32 v52, s53, v52
  v_and_b32 v53, s53, v53
  v_and_b32 v54, s53, v54
  v_and_b32 v55, s53, v55
  v_mul_f32 v52, s52, v52
  v_mul_f32 v53, s52, v53
  v_mul_f32 v54, s52, v54
  v_mul_f32 v55, s52, v55
  v_cvt_pk_bf16_f32 v52, v52, v52
  v_cvt_pk_bf16_f32 v53, v53, v53
  v_cvt_pk_bf16_f32 v54, v54, v54
  v_cvt_pk_bf16_f32 v55, v55, v55
  v_and_b32 v52, s53, v52
  v_and_b32 v53, s53, v53
  v_and_b32 v54, s53, v54
  v_and_b32 v55, s53, v55
  v_mul_f32 v40, s43, v52
  v_mul_f32 v41, s43, v53
  v_mul_f32 v42, s43, v54
  v_mul_f32 v43, s43, v55
  v_max3_f32 v18, v40, v41, v42
  v_max_f32 v18, v18, v43
  v_mov_b32 v19, v18
  s_nop 1
  v_permlane16_swap_b32 v18, v19
  v_max_f32 v18, v18, v19
  v_mov_b32 v19, v18
  s_nop 1
  v_permlane32_swap_b32 v18, v19
  v_max3_f32 v20, v18, v19, v154
  v_sub_f32 v22, v154, v20
  v_sub_f32 v24, v40, v20
  v_sub_f32 v25, v41, v20
  v_sub_f32 v26, v42, v20
  v_sub_f32 v27, v43, v20
  v_exp_f32 v22, v22
  v_exp_f32 v24, v24
  v_exp_f32 v25, v25
  v_exp_f32 v26, v26
  v_exp_f32 v27, v27
  v_mov_b32 v154, v20
  v_fma_f32 v155, v155, v22, v24
  v_pk_mul_f32 v[144:145], v[144:145], v[22:23] op_sel_hi:[1,0]
  v_pk_mul_f32 v[146:147], v[146:147], v[22:23] op_sel_hi:[1,0]
  v_pk_mul_f32 v[148:149], v[148:149], v[22:23] op_sel_hi:[1,0]
  v_pk_mul_f32 v[150:151], v[150:151], v[22:23] op_sel_hi:[1,0]
  v_add_f32 v155, v155, v25
  v_add_f32 v155, v155, v26
  v_add_f32 v155, v155, v27
  v_cvt_pk_bf16_f32 v40, v24, v24
  v_cvt_pk_bf16_f32 v41, v25, v25
  v_cvt_pk_bf16_f32 v42, v26, v26
  v_cvt_pk_bf16_f32 v43, v27, v27
  v_and_b32 v56, v40, v152
  v_and_b32 v57, v40, v153
  v_and_b32 v58, v41, v152
  v_and_b32 v59, v41, v153
  v_and_b32 v60, v42, v152
  v_and_b32 v61, v42, v153
  v_and_b32 v62, v43, v152
  v_and_b32 v63, v43, v153
  s_waitcnt vmcnt(4)
  buffer_load_dwordx4 v[80:83], v1, s[36:39], s48 offen offset:0 nt
  buffer_load_dwordx4 v[84:87], v1, s[36:39], s48 offen offset:1024 nt
  buffer_load_dwordx4 v[88:91], v1, s[36:39], s48 offen offset:2048 nt
  buffer_load_dwordx4 v[92:95], v1, s[36:39], s48 offen offset:3072 nt
  s_waitcnt vmcnt(8)
  s_waitcnt lgkmcnt(0)
  s_add_u32 s51, s45, 1
  s_cmp_lt_u32 s51, 256
  s_cbranch_scc1 L_moreB3
  s_mov_b32 s34, 0
  s_mov_b32 s38, 0
  s_branch L_nsB3
L_moreB3:
  s_lshl_b32 s49, s51, 12
  s_add_u32 s49, s49, s44
  s_mov_b32 s45, 1
  s_atomic_add s45, s[46:47], 0x0 glc
L_nsB3:
  s_nop 0
  v_mfma_f32_16x16x16_bf16 v[144:147], v[112:113], v[56:57], v[144:147]
  v_mfma_f32_16x16x16_bf16 v[148:151], v[114:115], v[56:57], v[148:151]
  v_mfma_f32_16x16x16_bf16 v[144:147], v[116:117], v[58:59], v[144:147]
  v_mfma_f32_16x16x16_bf16 v[148:151], v[118:119], v[58:59], v[148:151]
  v_mfma_f32_16x16x16_bf16 v[144:147], v[120:121], v[60:61], v[144:147]
  v_mfma_f32_16x16x16_bf16 v[148:151], v[122:123], v[60:61], v[148:151]
  v_mfma_f32_16x16x16_bf16 v[144:147], v[124:125], v[62:63], v[144:147]
  v_mfma_f32_16x16x16_bf16 v[148:151], v[126:127], v[62:63], v[148:151]
  s_waitcnt vmcnt(4)
  buffer_load_dwordx4 v[96:99], v1, s[32:35], s49 offen offset:0 nt
  buffer_load_dwordx4 v[100:103], v1, s[32:35], s49 offen offset:1024 nt
  buffer_load_dwordx4 v[104:107], v1, s[32:35], s49 offen offset:2048 nt
  buffer_load_dwordx4 v[108:111], v1, s[32:35], s49 offen offset:3072 nt
  s_cmp_lt_u32 s50, 256
  s_cbranch_scc1 L_loopB
L_finB:
  v_mov_b32 v18, v155
  v_mov_b32 v19, v155
  ds_write_b32 v30, v154 offset:5184
  s_nop 0
  v_permlane16_swap_b32 v18, v19
  v_add_f32 v18, v18, v19
  v_mov_b32 v19, v18
  ds_write_b32 v29, v144 offset:8192
  ds_write_b32 v29, v148 offset:8208
  ds_write_b32 v29, v145 offset:8224
  ds_write_b32 v29, v149 offset:8240
  ds_write_b32 v29, v146 offset:8256
  ds_write_b32 v29, v150 offset:8272
  ds_write_b32 v29, v147 offset:8288
  ds_write_b32 v29, v151 offset:8304
  v_permlane32_swap_b32 v18, v19
  v_add_f32 v18, v18, v19
  ds_write_b32 v30, v18 offset:5200
  s_waitcnt lgkmcnt(0)
  s_barrier
  s_endpgm
L_helper:
  s_setprio 3
  s_sub_u32 s62, s3, 4
  v_lshlrev_b32 v7, 4, v2
  s_lshl_b32 s49, s2, 2
  s_add_u32 s49, s49, s62
  s_lshl_b32 s49, s49, 10
  v_add_u32 v17, s49, v7
  v_add_u32 v103, 1048576, v17
  s_lshr_b32 s44, s49, 4
  s_add_u32 s44, s44, 2096192
  v_add_u32 v53, s44, v7
  v_cmp_gt_u32 vcc, 60, v2
  v_mov_b32 v116, -1
  v_mov_b32 v117, -1
  v_mov_b32 v118, -1
  v_mov_b32 v119, -1
  v_cndmask_b32 v53, v53, v17, vcc
  s_lshr_b32 s44, s2, 2
  s_mul_i32 s44, s44, 16384
  s_add_u32 s44, s44, 3145728
  v_writelane_b32 v53, s44, 40
  s_or_b32 s44, s30, s62
  s_cmp_eq_u32 s44, 0
  s_cselect_b32 s43, 0x100, 0
  s_or_b32 s43, s43, 0xf000000f
  v_lshrrev_b32 v4, 2, v2
  v_lshlrev_b32 v4, 4, v4
  v_and_b32 v44, 15, v2
  v_lshlrev_b32 v44, 4, v44
  v_lshrrev_b32 v45, 4, v2
  v_lshl_add_u32 v1, v45, 18, v44
  s_mov_b32 s34, 8192
  s_mov_b32 s35, 0x00020000
  s_mov_b32 s38, 4194304
  s_mov_b32 s39, 0x00020000
  s_lshl_b32 s46, s60, 10
  s_lshl_b32 s44, s62, 8
  s_add_u32 s46, s46, s44
  s_lshl_b32 s53, s62, 20
  s_lshl_b32 s44, s61, 8
  s_add_u32 s53, s53, s44
  s_waitcnt lgkmcnt(0)
  s_mov_b64 s[32:33], s[4:5]
  s_mov_b64 s[36:37], s[10:11]
  global_store_dwordx4 v103, v[116:119], s[28:29] sc1
  s_mov_b32 exec_hi, s43
  global_store_dwordx4 v53, v[116:119], s[28:29] sc1
  s_mov_b64 exec, -1
  buffer_load_dwordx4 v[108:111], v4, s[32:35], s46 offen
  buffer_load_dwordx4 v[128:131], v1, s[36:39], s53 offen offset:0
  s_add_u32 s44, s53, 65536
  buffer_load_dwordx4 v[132:135], v1, s[36:39], s44 offen offset:0
  s_add_u32 s44, s53, 131072
  buffer_load_dwordx4 v[136:139], v1, s[36:39], s44 offen offset:0
  s_add_u32 s44, s53, 196608
  buffer_load_dwordx4 v[140:143], v1, s[36:39], s44 offen offset:0
  s_add_u32 s44, s53, 8192
  buffer_load_dwordx4 v[144:147], v1, s[36:39], s44 offen offset:0
  s_add_u32 s44, s53, 73728
  buffer_load_dwordx4 v[148:151], v1, s[36:39], s44 offen offset:0
  s_add_u32 s44, s53, 139264
  buffer_load_dwordx4 v[152:155], v1, s[36:39], s44 offen offset:0
  s_add_u32 s44, s53, 204800
  buffer_load_dwordx4 v[156:159], v1, s[36:39], s44 offen offset:0
  s_add_u32 s44, s53, 16384
  buffer_load_dwordx4 v[160:163], v1, s[36:39], s44 offen offset:0
  s_add_u32 s44, s53, 81920
  buffer_load_dwordx4 v[164:167], v1, s[36:39], s44 offen offset:0
  s_add_u32 s44, s53, 147456
  buffer_load_dwordx4 v[168:171], v1, s[36:39], s44 offen offset:0
  s_add_u32 s44, s53, 212992
  buffer_load_dwordx4 v[172:175], v1, s[36:39], s44 offen offset:0
  s_add_u32 s44, s53, 24576
  buffer_load_dwordx4 v[176:179], v1, s[36:39], s44 offen offset:0
  s_add_u32 s44, s53, 90112
  buffer_load_dwordx4 v[180:183], v1, s[36:39], s44 offen offset:0
  s_add_u32 s44, s53, 155648
  buffer_load_dwordx4 v[184:187], v1, s[36:39], s44 offen offset:0
  s_add_u32 s44, s53, 221184
  buffer_load_dwordx4 v[188:191], v1, s[36:39], s44 offen offset:0
  s_add_u32 s44, s53, 32768
  buffer_load_dwordx4 v[192:195], v1, s[36:39], s44 offen offset:0
  s_add_u32 s44, s53, 98304
  buffer_load_dwordx4 v[196:199], v1, s[36:39], s44 offen offset:0
  s_add_u32 s44, s53, 163840
  buffer_load_dwordx4 v[200:203], v1, s[36:39], s44 offen offset:0
  s_add_u32 s44, s53, 229376
  buffer_load_dwordx4 v[204:207], v1, s[36:39], s44 offen offset:0
  s_add_u32 s44, s53, 40960
  buffer_load_dwordx4 v[208:211], v1, s[36:39], s44 offen offset:0
  s_add_u32 s44, s53, 106496
  buffer_load_dwordx4 v[212:215], v1, s[36:39], s44 offen offset:0
  s_add_u32 s44, s53, 172032
  buffer_load_dwordx4 v[216:219], v1, s[36:39], s44 offen offset:0
  s_add_u32 s44, s53, 237568
  buffer_load_dwordx4 v[220:223], v1, s[36:39], s44 offen offset:0
  s_add_u32 s44, s53, 49152
  buffer_load_dwordx4 v[224:227], v1, s[36:39], s44 offen offset:0
  s_add_u32 s44, s53, 114688
  buffer_load_dwordx4 v[228:231], v1, s[36:39], s44 offen offset:0
  s_add_u32 s44, s53, 180224
  buffer_load_dwordx4 v[232:235], v1, s[36:39], s44 offen offset:0
  s_add_u32 s44, s53, 245760
  buffer_load_dwordx4 v[236:239], v1, s[36:39], s44 offen offset:0
  s_add_u32 s44, s53, 57344
  buffer_load_dwordx4 v[240:243], v1, s[36:39], s44 offen offset:0
  s_add_u32 s44, s53, 122880
  buffer_load_dwordx4 v[244:247], v1, s[36:39], s44 offen offset:0
  s_add_u32 s44, s53, 188416
  buffer_load_dwordx4 v[248:251], v1, s[36:39], s44 offen offset:0
  s_add_u32 s44, s53, 253952
  buffer_load_dwordx4 v[252:255], v1, s[36:39], s44 offen offset:0
  s_barrier
  v_and_b32 v44, 1, v2
  v_cmp_eq_u32 vcc, 1, v44
  v_mov_b32 v44, 0xffff
  v_mov_b32 v45, 0xffff0000
  v_cndmask_b32 v44, v44, v45, vcc
  v_bfe_u32 v45, v2, 1, 3
  v_cmp_eq_u32 vcc, 0, v45
  s_nop 1
  v_cndmask_b32 v8, 0, v44, vcc
  v_cmp_eq_u32 vcc, 1, v45
  s_nop 1
  v_cndmask_b32 v9, 0, v44, vcc
  v_cmp_eq_u32 vcc, 2, v45
  s_nop 1
  v_cndmask_b32 v10, 0, v44, vcc
  v_cmp_eq_u32 vcc, 3, v45
  s_nop 1
  v_cndmask_b32 v11, 0, v44, vcc
  v_cmp_eq_u32 vcc, 4, v45
  s_nop 1
  v_cndmask_b32 v12, 0, v44, vcc
  v_cmp_eq_u32 vcc, 5, v45
  s_nop 1
  v_cndmask_b32 v13, 0, v44, vcc
  v_cmp_eq_u32 vcc, 6, v45
  s_nop 1
  v_cndmask_b32 v14, 0, v44, vcc
  v_cmp_eq_u32 vcc, 7, v45
  s_nop 1
  v_cndmask_b32 v15, 0, v44, vcc
  s_mov_b32 s40, 0x01000100
  s_mov_b32 s41, 0x03020302
  v_mov_b32 v28, 0
  v_mov_b32 v29, 0
  v_mov_b32 v30, 0
  v_mov_b32 v31, 0
  v_mov_b32 v32, 0
  v_mov_b32 v33, 0
  v_mov_b32 v34, 0
  v_mov_b32 v35, 0
  v_bfe_u32 v44, v2, 2, 2
  v_lshrrev_b32 v45, 4, v2
  v_and_b32 v6, 3, v2
  v_lshl_add_u32 v6, v44, 3, v6
  v_lshl_add_u32 v6, v45, 5, v6
  s_lshl_b32 s44, s62, 9
  v_lshlrev_b32 v6, 2, v6
  v_add_u32 v6, s44, v6
  v_mov_b32 v44, 0
  v_mov_b32 v45, 5376
  ds_write_b32 v45, v44
  s_waitcnt vmcnt(32)
  v_perm_b32 v20, v108, v108, s40
  v_perm_b32 v21, v108, v108, s41
  v_perm_b32 v22, v109, v109, s40
  v_perm_b32 v23, v109, v109, s41
  v_perm_b32 v24, v110, v110, s40
  v_perm_b32 v25, v110, v110, s41
  v_perm_b32 v26, v111, v111, s40
  v_perm_b32 v27, v111, v111, s41
  s_waitcnt vmcnt(28)
  v_and_b32 v36, v20, v8
  v_and_b32 v37, v20, v9
  v_and_b32 v38, v20, v10
  v_and_b32 v39, v20, v11
  v_and_b32 v40, v20, v12
  v_and_b32 v41, v20, v13
  v_and_b32 v42, v20, v14
  v_and_b32 v43, v20, v15
  v_mfma_f32_16x16x16_bf16 v[28:31], v[128:129], v[36:37], v[28:31]
  v_mfma_f32_16x16x16_bf16 v[32:35], v[130:131], v[36:37], v[32:35]
  v_mfma_f32_16x16x16_bf16 v[28:31], v[132:133], v[38:39], v[28:31]
  v_mfma_f32_16x16x16_bf16 v[32:35], v[134:135], v[38:39], v[32:35]
  v_mfma_f32_16x16x16_bf16 v[28:31], v[136:137], v[40:41], v[28:31]
  v_mfma_f32_16x16x16_bf16 v[32:35], v[138:139], v[40:41], v[32:35]
  v_mfma_f32_16x16x16_bf16 v[28:31], v[140:141], v[42:43], v[28:31]
  v_mfma_f32_16x16x16_bf16 v[32:35], v[142:143], v[42:43], v[32:35]
  s_waitcnt vmcnt(24)
  v_and_b32 v36, v21, v8
  v_and_b32 v37, v21, v9
  v_and_b32 v38, v21, v10
  v_and_b32 v39, v21, v11
  v_and_b32 v40, v21, v12
  v_and_b32 v41, v21, v13
  v_and_b32 v42, v21, v14
  v_and_b32 v43, v21, v15
  v_mfma_f32_16x16x16_bf16 v[28:31], v[144:145], v[36:37], v[28:31]
  v_mfma_f32_16x16x16_bf16 v[32:35], v[146:147], v[36:37], v[32:35]
  v_mfma_f32_16x16x16_bf16 v[28:31], v[148:149], v[38:39], v[28:31]
  v_mfma_f32_16x16x16_bf16 v[32:35], v[150:151], v[38:39], v[32:35]
  v_mfma_f32_16x16x16_bf16 v[28:31], v[152:153], v[40:41], v[28:31]
  v_mfma_f32_16x16x16_bf16 v[32:35], v[154:155], v[40:41], v[32:35]
  v_mfma_f32_16x16x16_bf16 v[28:31], v[156:157], v[42:43], v[28:31]
  v_mfma_f32_16x16x16_bf16 v[32:35], v[158:159], v[42:43], v[32:35]
  s_waitcnt vmcnt(20)
  v_and_b32 v36, v22, v8
  v_and_b32 v37, v22, v9
  v_and_b32 v38, v22, v10
  v_and_b32 v39, v22, v11
  v_and_b32 v40, v22, v12
  v_and_b32 v41, v22, v13
  v_and_b32 v42, v22, v14
  v_and_b32 v43, v22, v15
  v_mfma_f32_16x16x16_bf16 v[28:31], v[160:161], v[36:37], v[28:31]
  v_mfma_f32_16x16x16_bf16 v[32:35], v[162:163], v[36:37], v[32:35]
  v_mfma_f32_16x16x16_bf16 v[28:31], v[164:165], v[38:39], v[28:31]
  v_mfma_f32_16x16x16_bf16 v[32:35], v[166:167], v[38:39], v[32:35]
  v_mfma_f32_16x16x16_bf16 v[28:31], v[168:169], v[40:41], v[28:31]
  v_mfma_f32_16x16x16_bf16 v[32:35], v[170:171], v[40:41], v[32:35]
  v_mfma_f32_16x16x16_bf16 v[28:31], v[172:173], v[42:43], v[28:31]
  v_mfma_f32_16x16x16_bf16 v[32:35], v[174:175], v[42:43], v[32:35]
  s_waitcnt vmcnt(16)
  v_and_b32 v36, v23, v8
  v_and_b32 v37, v23, v9
  v_and_b32 v38, v23, v10
  v_and_b32 v39, v23, v11
  v_and_b32 v40, v23, v12
  v_and_b32 v41, v23, v13
  v_and_b32 v42, v23, v14
  v_and_b32 v43, v23, v15
  v_mfma_f32_16x16x16_bf16 v[28:31], v[176:177], v[36:37], v[28:31]
  v_mfma_f32_16x16x16_bf16 v[32:35], v[178:179], v[36:37], v[32:35]
  v_mfma_f32_16x16x16_bf16 v[28:31], v[180:181], v[38:39], v[28:31]
  v_mfma_f32_16x16x16_bf16 v[32:35], v[182:183], v[38:39], v[32:35]
  v_mfma_f32_16x16x16_bf16 v[28:31], v[184:185], v[40:41], v[28:31]
  v_mfma_f32_16x16x16_bf16 v[32:35], v[186:187], v[40:41], v[32:35]
  v_mfma_f32_16x16x16_bf16 v[28:31], v[188:189], v[42:43], v[28:31]
  v_mfma_f32_16x16x16_bf16 v[32:35], v[190:191], v[42:43], v[32:35]
  s_waitcnt vmcnt(12)
  v_and_b32 v36, v24, v8
  v_and_b32 v37, v24, v9
  v_and_b32 v38, v24, v10
  v_and_b32 v39, v24, v11
  v_and_b32 v40, v24, v12
  v_and_b32 v41, v24, v13
  v_and_b32 v42, v24, v14
  v_and_b32 v43, v24, v15
  v_mfma_f32_16x16x16_bf16 v[28:31], v[192:193], v[36:37], v[28:31]
  v_mfma_f32_16x16x16_bf16 v[32:35], v[194:195], v[36:37], v[32:35]
  v_mfma_f32_16x16x16_bf16 v[28:31], v[196:197], v[38:39], v[28:31]
  v_mfma_f32_16x16x16_bf16 v[32:35], v[198:199], v[38:39], v[32:35]
  v_mfma_f32_16x16x16_bf16 v[28:31], v[200:201], v[40:41], v[28:31]
  v_mfma_f32_16x16x16_bf16 v[32:35], v[202:203], v[40:41], v[32:35]
  v_mfma_f32_16x16x16_bf16 v[28:31], v[204:205], v[42:43], v[28:31]
  v_mfma_f32_16x16x16_bf16 v[32:35], v[206:207], v[42:43], v[32:35]
  s_waitcnt vmcnt(8)
  v_and_b32 v36, v25, v8
  v_and_b32 v37, v25, v9
  v_and_b32 v38, v25, v10
  v_and_b32 v39, v25, v11
  v_and_b32 v40, v25, v12
  v_and_b32 v41, v25, v13
  v_and_b32 v42, v25, v14
  v_and_b32 v43, v25, v15
  v_mfma_f32_16x16x16_bf16 v[28:31], v[208:209], v[36:37], v[28:31]
  v_mfma_f32_16x16x16_bf16 v[32:35], v[210:211], v[36:37], v[32:35]
  v_mfma_f32_16x16x16_bf16 v[28:31], v[212:213], v[38:39], v[28:31]
  v_mfma_f32_16x16x16_bf16 v[32:35], v[214:215], v[38:39], v[32:35]
  v_mfma_f32_16x16x16_bf16 v[28:31], v[216:217], v[40:41], v[28:31]
  v_mfma_f32_16x16x16_bf16 v[32:35], v[218:219], v[40:41], v[32:35]
  v_mfma_f32_16x16x16_bf16 v[28:31], v[220:221], v[42:43], v[28:31]
  v_mfma_f32_16x16x16_bf16 v[32:35], v[222:223], v[42:43], v[32:35]
  s_waitcnt vmcnt(4)
  v_and_b32 v36, v26, v8
  v_and_b32 v37, v26, v9
  v_and_b32 v38, v26, v10
  v_and_b32 v39, v26, v11
  v_and_b32 v40, v26, v12
  v_and_b32 v41, v26, v13
  v_and_b32 v42, v26, v14
  v_and_b32 v43, v26, v15
  v_mfma_f32_16x16x16_bf16 v[28:31], v[224:225], v[36:37], v[28:31]
  v_mfma_f32_16x16x16_bf16 v[32:35], v[226:227], v[36:37], v[32:35]
  v_mfma_f32_16x16x16_bf16 v[28:31], v[228:229], v[38:39], v[28:31]
  v_mfma_f32_16x16x16_bf16 v[32:35], v[230:231], v[38:39], v[32:35]
  v_mfma_f32_16x16x16_bf16 v[28:31], v[232:233], v[40:41], v[28:31]
  v_mfma_f32_16x16x16_bf16 v[32:35], v[234:235], v[40:41], v[32:35]
  v_mfma_f32_16x16x16_bf16 v[28:31], v[236:237], v[42:43], v[28:31]
  v_mfma_f32_16x16x16_bf16 v[32:35], v[238:239], v[42:43], v[32:35]
  s_waitcnt vmcnt(0)
  v_and_b32 v36, v27, v8
  v_and_b32 v37, v27, v9
  v_and_b32 v38, v27, v10
  v_and_b32 v39, v27, v11
  v_and_b32 v40, v27, v12
  v_and_b32 v41, v27, v13
  v_and_b32 v42, v27, v14
  v_and_b32 v43, v27, v15
  v_mfma_f32_16x16x16_bf16 v[28:31], v[240:241], v[36:37], v[28:31]
  v_mfma_f32_16x16x16_bf16 v[32:35], v[242:243], v[36:37], v[32:35]
  v_mfma_f32_16x16x16_bf16 v[28:31], v[244:245], v[38:39], v[28:31]
  v_mfma_f32_16x16x16_bf16 v[32:35], v[246:247], v[38:39], v[32:35]
  v_mfma_f32_16x16x16_bf16 v[28:31], v[248:249], v[40:41], v[28:31]
  v_mfma_f32_16x16x16_bf16 v[32:35], v[250:251], v[40:41], v[32:35]
  v_mfma_f32_16x16x16_bf16 v[28:31], v[252:253], v[42:43], v[28:31]
  v_mfma_f32_16x16x16_bf16 v[32:35], v[254:255], v[42:43], v[32:35]
  s_nop 7
  v_add_f32_dpp v46, v28, v28 row_ror:8 row_mask:0xf bank_mask:0x3
  v_add_f32_dpp v47, v29, v29 row_ror:8 row_mask:0xf bank_mask:0x3
  v_add_f32_dpp v46, v30, v30 row_ror:8 row_mask:0xf bank_mask:0xc
  v_add_f32_dpp v47, v31, v31 row_ror:8 row_mask:0xf bank_mask:0xc
  s_nop 0
  v_add_f32_dpp v44, v46, v46 row_shl:4 row_mask:0xf bank_mask:0x5
  v_add_f32_dpp v44, v47, v47 row_shr:4 row_mask:0xf bank_mask:0xa
  v_add_f32_dpp v48, v32, v32 row_ror:8 row_mask:0xf bank_mask:0x3
  v_add_f32_dpp v49, v33, v33 row_ror:8 row_mask:0xf bank_mask:0x3
  v_add_f32_dpp v48, v34, v34 row_ror:8 row_mask:0xf bank_mask:0xc
  v_add_f32_dpp v49, v35, v35 row_ror:8 row_mask:0xf bank_mask:0xc
  s_nop 0
  v_add_f32_dpp v45, v48, v48 row_shl:4 row_mask:0xf bank_mask:0x5
  v_add_f32_dpp v45, v49, v49 row_shr:4 row_mask:0xf bank_mask:0xa
  ds_write_b32 v6, v44 offset:0
  ds_write_b32 v6, v45 offset:16
  s_waitcnt lgkmcnt(0)
  s_barrier
  s_mov_b64 s[32:33], s[14:15]
  s_mov_b64 s[36:37], s[20:21]
  s_lshl_b32 s53, s62, 20
  s_lshl_b32 s44, s31, 8
  s_add_u32 s53, s53, s44
  v_mov_b32 v28, 0
  v_mov_b32 v29, 0
  v_mov_b32 v30, 0
  v_mov_b32 v31, 0
  v_mov_b32 v32, 0
  v_mov_b32 v33, 0
  v_mov_b32 v34, 0
  v_mov_b32 v35, 0
  buffer_load_dwordx4 v[108:111], v4, s[32:35], s46 offen
  buffer_load_dwordx4 v[128:131], v1, s[36:39], s53 offen offset:0
  s_add_u32 s44, s53, 65536
  buffer_load_dwordx4 v[132:135], v1, s[36:39], s44 offen offset:0
  s_add_u32 s44, s53, 131072
  buffer_load_dwordx4 v[136:139], v1, s[36:39], s44 offen offset:0
  s_add_u32 s44, s53, 196608
  buffer_load_dwordx4 v[140:143], v1, s[36:39], s44 offen offset:0
  s_lshl_b32 s44, s60, 5
  s_add_u32 s54, s26, s44
  s_addc_u32 s55, s27, 0
  s_lshl_b32 s44, s60, 10
  s_add_u32 s44, s44, s31
  s_lshl_b32 s44, s44, 7
  s_add_u32 s44, s44, 1048576
  v_lshrrev_b32 v120, 3, v2
  v_lshlrev_b32 v120, 12, v120
  v_and_b32 v44, 7, v2
  v_lshl_add_u32 v120, v44, 4, v120
  v_add_u32 v120, s44, v120
  v_add_u32 v121, 32768, v120
  v_add_u32 v122, 65536, v120
  v_add_u32 v123, 98304, v120
  v_and_b32 v124, 7, v2
  v_bfe_u32 v44, v2, 4, 1
  v_lshl_add_u32 v124, v44, 4, v124
  v_bfe_u32 v44, v2, 3, 1
  v_lshl_add_u32 v124, v44, 9, v124
  s_lshr_b32 s44, s31, 1
  s_lshl_b32 s44, s44, 5
  s_and_b32 s43, s31, 1
  s_lshl_b32 s43, s43, 3
  s_add_u32 s44, s44, s43
  s_lshl_b32 s43, s60, 10
  s_add_u32 s44, s44, s43
  v_add_lshl_u32 v124, v124, s44, 1
  v_lshlrev_b32 v100, 3, v2
  v_mov_b32 v102, 0
  v_mov_b32 v104, 0x7fc07fc0
  s_lshl_b32 s44, s62, 9
  v_add_u32 v101, s44, v7
  s_lshl_b32 s44, s62, 5
  v_mov_b32 v105, s44
  s_andn2_b32 s44, s2, 3
  s_add_u32 s44, s44, s62
  s_lshl_b32 s44, s44, 2
  s_add_u32 s44, s44, s30
  s_lshl_b32 s44, s44, 10
  v_add_u32 v16, s44, v7
  s_mul_i32 s44, s62, 640
  v_add_u32 v125, s44, v7
  s_waitcnt vmcnt(4)
  v_perm_b32 v20, v108, v108, s40
  v_perm_b32 v21, v108, v108, s41
  v_perm_b32 v22, v109, v109, s40
  v_perm_b32 v23, v109, v109, s41
  v_perm_b32 v24, v110, v110, s40
  v_perm_b32 v25, v110, v110, s41
  v_perm_b32 v26, v111, v111, s40
  v_perm_b32 v27, v111, v111, s41
  s_waitcnt vmcnt(0)
  s_add_u32 s44, s53, 8192
  buffer_load_dwordx4 v[144:147], v1, s[36:39], s44 offen offset:0
  s_add_u32 s44, s53, 73728
  buffer_load_dwordx4 v[148:151], v1, s[36:39], s44 offen offset:0
  s_add_u32 s44, s53, 139264
  buffer_load_dwordx4 v[152:155], v1, s[36:39], s44 offen offset:0
  s_add_u32 s44, s53, 204800
  buffer_load_dwordx4 v[156:159], v1, s[36:39], s44 offen offset:0
  v_and_b32 v36, v20, v8
  v_and_b32 v37, v20, v9
  v_and_b32 v38, v20, v10
  v_and_b32 v39, v20, v11
  v_and_b32 v40, v20, v12
  v_and_b32 v41, v20, v13
  v_and_b32 v42, v20, v14
  v_and_b32 v43, v20, v15
  v_mfma_f32_16x16x16_bf16 v[28:31], v[128:129], v[36:37], v[28:31]
  v_mfma_f32_16x16x16_bf16 v[32:35], v[130:131], v[36:37], v[32:35]
  v_mfma_f32_16x16x16_bf16 v[28:31], v[132:133], v[38:39], v[28:31]
  v_mfma_f32_16x16x16_bf16 v[32:35], v[134:135], v[38:39], v[32:35]
  v_mfma_f32_16x16x16_bf16 v[28:31], v[136:137], v[40:41], v[28:31]
  v_mfma_f32_16x16x16_bf16 v[32:35], v[138:139], v[40:41], v[32:35]
  v_mfma_f32_16x16x16_bf16 v[28:31], v[140:141], v[42:43], v[28:31]
  v_mfma_f32_16x16x16_bf16 v[32:35], v[142:143], v[42:43], v[32:35]
  s_waitcnt vmcnt(0)
  s_add_u32 s44, s53, 16384
  buffer_load_dwordx4 v[160:163], v1, s[36:39], s44 offen offset:0
  s_add_u32 s44, s53, 81920
  buffer_load_dwordx4 v[164:167], v1, s[36:39], s44 offen offset:0
  s_add_u32 s44, s53, 147456
  buffer_load_dwordx4 v[168:171], v1, s[36:39], s44 offen offset:0
  s_add_u32 s44, s53, 212992
  buffer_load_dwordx4 v[172:175], v1, s[36:39], s44 offen offset:0
  v_and_b32 v36, v21, v8
  v_and_b32 v37, v21, v9
  v_and_b32 v38, v21, v10
  v_and_b32 v39, v21, v11
  v_and_b32 v40, v21, v12
  v_and_b32 v41, v21, v13
  v_and_b32 v42, v21, v14
  v_and_b32 v43, v21, v15
  v_mfma_f32_16x16x16_bf16 v[28:31], v[144:145], v[36:37], v[28:31]
  v_mfma_f32_16x16x16_bf16 v[32:35], v[146:147], v[36:37], v[32:35]
  v_mfma_f32_16x16x16_bf16 v[28:31], v[148:149], v[38:39], v[28:31]
  v_mfma_f32_16x16x16_bf16 v[32:35], v[150:151], v[38:39], v[32:35]
  v_mfma_f32_16x16x16_bf16 v[28:31], v[152:153], v[40:41], v[28:31]
  v_mfma_f32_16x16x16_bf16 v[32:35], v[154:155], v[40:41], v[32:35]
  v_mfma_f32_16x16x16_bf16 v[28:31], v[156:157], v[42:43], v[28:31]
  v_mfma_f32_16x16x16_bf16 v[32:35], v[158:159], v[42:43], v[32:35]
  s_waitcnt vmcnt(0)
  s_add_u32 s44, s53, 24576
  buffer_load_dwordx4 v[176:179], v1, s[36:39], s44 offen offset:0
  s_add_u32 s44, s53, 90112
  buffer_load_dwordx4 v[180:183], v1, s[36:39], s44 offen offset:0
  s_add_u32 s44, s53, 155648
  buffer_load_dwordx4 v[184:187], v1, s[36:39], s44 offen offset:0
  s_add_u32 s44, s53, 221184
  buffer_load_dwordx4 v[188:191], v1, s[36:39], s44 offen offset:0
  v_and_b32 v36, v22, v8
  v_and_b32 v37, v22, v9
  v_and_b32 v38, v22, v10
  v_and_b32 v39, v22, v11
  v_and_b32 v40, v22, v12
  v_and_b32 v41, v22, v13
  v_and_b32 v42, v22, v14
  v_and_b32 v43, v22, v15
  v_mfma_f32_16x16x16_bf16 v[28:31], v[160:161], v[36:37], v[28:31]
  v_mfma_f32_16x16x16_bf16 v[32:35], v[162:163], v[36:37], v[32:35]
  v_mfma_f32_16x16x16_bf16 v[28:31], v[164:165], v[38:39], v[28:31]
  v_mfma_f32_16x16x16_bf16 v[32:35], v[166:167], v[38:39], v[32:35]
  v_mfma_f32_16x16x16_bf16 v[28:31], v[168:169], v[40:41], v[28:31]
  v_mfma_f32_16x16x16_bf16 v[32:35], v[170:171], v[40:41], v[32:35]
  v_mfma_f32_16x16x16_bf16 v[28:31], v[172:173], v[42:43], v[28:31]
  v_mfma_f32_16x16x16_bf16 v[32:35], v[174:175], v[42:43], v[32:35]
  s_waitcnt vmcnt(0)
  s_add_u32 s44, s53, 32768
  buffer_load_dwordx4 v[192:195], v1, s[36:39], s44 offen offset:0
  s_add_u32 s44, s53, 98304
  buffer_load_dwordx4 v[196:199], v1, s[36:39], s44 offen offset:0
  s_add_u32 s44, s53, 163840
  buffer_load_dwordx4 v[200:203], v1, s[36:39], s44 offen offset:0
  s_add_u32 s44, s53, 229376
  buffer_load_dwordx4 v[204:207], v1, s[36:39], s44 offen offset:0
  v_and_b32 v36, v23, v8
  v_and_b32 v37, v23, v9
  v_and_b32 v38, v23, v10
  v_and_b32 v39, v23, v11
  v_and_b32 v40, v23, v12
  v_and_b32 v41, v23, v13
  v_and_b32 v42, v23, v14
  v_and_b32 v43, v23, v15
  v_mfma_f32_16x16x16_bf16 v[28:31], v[176:177], v[36:37], v[28:31]
  v_mfma_f32_16x16x16_bf16 v[32:35], v[178:179], v[36:37], v[32:35]
  v_mfma_f32_16x16x16_bf16 v[28:31], v[180:181], v[38:39], v[28:31]
  v_mfma_f32_16x16x16_bf16 v[32:35], v[182:183], v[38:39], v[32:35]
  v_mfma_f32_16x16x16_bf16 v[28:31], v[184:185], v[40:41], v[28:31]
  v_mfma_f32_16x16x16_bf16 v[32:35], v[186:187], v[40:41], v[32:35]
  v_mfma_f32_16x16x16_bf16 v[28:31], v[188:189], v[42:43], v[28:31]
  v_mfma_f32_16x16x16_bf16 v[32:35], v[190:191], v[42:43], v[32:35]
  s_waitcnt vmcnt(0)
  s_add_u32 s44, s53, 40960
  buffer_load_dwordx4 v[208:211], v1, s[36:39], s44 offen offset:0
  s_add_u32 s44, s53, 106496
  buffer_load_dwordx4 v[212:215], v1, s[36:39], s44 offen offset:0
  s_add_u32 s44, s53, 172032
  buffer_load_dwordx4 v[216:219], v1, s[36:39], s44 offen offset:0
  s_add_u32 s44, s53, 237568
  buffer_load_dwordx4 v[220:223], v1, s[36:39], s44 offen offset:0
  v_and_b32 v36, v24, v8
  v_and_b32 v37, v24, v9
  v_and_b32 v38, v24, v10
  v_and_b32 v39, v24, v11
  v_and_b32 v40, v24, v12
  v_and_b32 v41, v24, v13
  v_and_b32 v42, v24, v14
  v_and_b32 v43, v24, v15
  v_mfma_f32_16x16x16_bf16 v[28:31], v[192:193], v[36:37], v[28:31]
  v_mfma_f32_16x16x16_bf16 v[32:35], v[194:195], v[36:37], v[32:35]
  v_mfma_f32_16x16x16_bf16 v[28:31], v[196:197], v[38:39], v[28:31]
  v_mfma_f32_16x16x16_bf16 v[32:35], v[198:199], v[38:39], v[32:35]
  v_mfma_f32_16x16x16_bf16 v[28:31], v[200:201], v[40:41], v[28:31]
  v_mfma_f32_16x16x16_bf16 v[32:35], v[202:203], v[40:41], v[32:35]
  v_mfma_f32_16x16x16_bf16 v[28:31], v[204:205], v[42:43], v[28:31]
  v_mfma_f32_16x16x16_bf16 v[32:35], v[206:207], v[42:43], v[32:35]
  s_waitcnt vmcnt(0)
  s_add_u32 s44, s53, 49152
  buffer_load_dwordx4 v[224:227], v1, s[36:39], s44 offen offset:0
  s_add_u32 s44, s53, 114688
  buffer_load_dwordx4 v[228:231], v1, s[36:39], s44 offen offset:0
  s_add_u32 s44, s53, 180224
  buffer_load_dwordx4 v[232:235], v1, s[36:39], s44 offen offset:0
  s_add_u32 s44, s53, 245760
  buffer_load_dwordx4 v[236:239], v1, s[36:39], s44 offen offset:0
  v_and_b32 v36, v25, v8
  v_and_b32 v37, v25, v9
  v_and_b32 v38, v25, v10
  v_and_b32 v39, v25, v11
  v_and_b32 v40, v25, v12
  v_and_b32 v41, v25, v13
  v_and_b32 v42, v25, v14
  v_and_b32 v43, v25, v15
  v_mfma_f32_16x16x16_bf16 v[28:31], v[208:209], v[36:37], v[28:31]
  v_mfma_f32_16x16x16_bf16 v[32:35], v[210:211], v[36:37], v[32:35]
  v_mfma_f32_16x16x16_bf16 v[28:31], v[212:213], v[38:39], v[28:31]
  v_mfma_f32_16x16x16_bf16 v[32:35], v[214:215], v[38:39], v[32:35]
  v_mfma_f32_16x16x16_bf16 v[28:31], v[216:217], v[40:41], v[28:31]
  v_mfma_f32_16x16x16_bf16 v[32:35], v[218:219], v[40:41], v[32:35]
  v_mfma_f32_16x16x16_bf16 v[28:31], v[220:221], v[42:43], v[28:31]
  v_mfma_f32_16x16x16_bf16 v[32:35], v[222:223], v[42:43], v[32:35]
  s_waitcnt vmcnt(0)
  s_add_u32 s44, s53, 57344
  buffer_load_dwordx4 v[240:243], v1, s[36:39], s44 offen offset:0
  s_add_u32 s44, s53, 122880
  buffer_load_dwordx4 v[244:247], v1, s[36:39], s44 offen offset:0
  s_add_u32 s44, s53, 188416
  buffer_load_dwordx4 v[248:251], v1, s[36:39], s44 offen offset:0
  s_add_u32 s44, s53, 253952
  buffer_load_dwordx4 v[252:255], v1, s[36:39], s44 offen offset:0
  v_and_b32 v36, v26, v8
  v_and_b32 v37, v26, v9
  v_and_b32 v38, v26, v10
  v_and_b32 v39, v26, v11
  v_and_b32 v40, v26, v12
  v_and_b32 v41, v26, v13
  v_and_b32 v42, v26, v14
  v_and_b32 v43, v26, v15
  v_mfma_f32_16x16x16_bf16 v[28:31], v[224:225], v[36:37], v[28:31]
  v_mfma_f32_16x16x16_bf16 v[32:35], v[226:227], v[36:37], v[32:35]
  v_mfma_f32_16x16x16_bf16 v[28:31], v[228:229], v[38:39], v[28:31]
  v_mfma_f32_16x16x16_bf16 v[32:35], v[230:231], v[38:39], v[32:35]
  v_mfma_f32_16x16x16_bf16 v[28:31], v[232:233], v[40:41], v[28:31]
  v_mfma_f32_16x16x16_bf16 v[32:35], v[234:235], v[40:41], v[32:35]
  v_mfma_f32_16x16x16_bf16 v[28:31], v[236:237], v[42:43], v[28:31]
  v_mfma_f32_16x16x16_bf16 v[32:35], v[238:239], v[42:43], v[32:35]
  s_waitcnt vmcnt(0)
  v_and_b32 v36, v27, v8
  v_and_b32 v37, v27, v9
  v_and_b32 v38, v27, v10
  v_and_b32 v39, v27, v11
  v_and_b32 v40, v27, v12
  v_and_b32 v41, v27, v13
  v_and_b32 v42, v27, v14
  v_and_b32 v43, v27, v15
  v_mfma_f32_16x16x16_bf16 v[28:31], v[240:241], v[36:37], v[28:31]
  v_mfma_f32_16x16x16_bf16 v[32:35], v[242:243], v[36:37], v[32:35]
  v_mfma_f32_16x16x16_bf16 v[28:31], v[244:245], v[38:39], v[28:31]
  v_mfma_f32_16x16x16_bf16 v[32:35], v[246:247], v[38:39], v[32:35]
  v_mfma_f32_16x16x16_bf16 v[28:31], v[248:249], v[40:41], v[28:31]
  v_mfma_f32_16x16x16_bf16 v[32:35], v[250:251], v[40:41], v[32:35]
  v_mfma_f32_16x16x16_bf16 v[28:31], v[252:253], v[42:43], v[28:31]
  v_mfma_f32_16x16x16_bf16 v[32:35], v[254:255], v[42:43], v[32:35]
  s_nop 7
  v_add_f32_dpp v46, v28, v28 row_ror:8 row_mask:0xf bank_mask:0x3
  v_add_f32_dpp v47, v29, v29 row_ror:8 row_mask:0xf bank_mask:0x3
  v_add_f32_dpp v46, v30, v30 row_ror:8 row_mask:0xf bank_mask:0xc
  v_add_f32_dpp v47, v31, v31 row_ror:8 row_mask:0xf bank_mask:0xc
  s_nop 0
  v_add_f32_dpp v44, v46, v46 row_shl:4 row_mask:0xf bank_mask:0x5
  v_add_f32_dpp v44, v47, v47 row_shr:4 row_mask:0xf bank_mask:0xa
  v_add_f32_dpp v48, v32, v32 row_ror:8 row_mask:0xf bank_mask:0x3
  v_add_f32_dpp v49, v33, v33 row_ror:8 row_mask:0xf bank_mask:0x3
  v_add_f32_dpp v48, v34, v34 row_ror:8 row_mask:0xf bank_mask:0xc
  v_add_f32_dpp v49, v35, v35 row_ror:8 row_mask:0xf bank_mask:0xc
  s_nop 0
  v_add_f32_dpp v45, v48, v48 row_shl:4 row_mask:0xf bank_mask:0x5
  v_add_f32_dpp v45, v49, v49 row_shr:4 row_mask:0xf bank_mask:0xa
  ds_write_b32 v6, v44 offset:5632
  ds_write_b32 v6, v45 offset:5648
  v_mov_b32 v46, 5376
  v_mov_b32 v47, 1
  s_waitcnt lgkmcnt(0)
  s_mov_b64 exec, 1
  ds_add_rtn_u32 v48, v46, v47
  s_mov_b64 exec, -1
  s_waitcnt lgkmcnt(0)
  v_readfirstlane_b32 s43, v48
  s_cmp_lg_u32 s43, 3
  s_cbranch_scc1 L_noq
  v_lshlrev_b32 v44, 1, v7
  v_mov_b32 v52, s2
  s_mov_b64 exec, 0xffff
  ds_read_b128 v[68:71], v44 offset:5632
  ds_read_b128 v[72:75], v44 offset:5648
  ds_read_b128 v[76:79], v44 offset:6144
  ds_read_b128 v[80:83], v44 offset:6160
  ds_read_b128 v[84:87], v44 offset:6656
  ds_read_b128 v[88:91], v44 offset:6672
  ds_read_b128 v[92:95], v44 offset:7168
  ds_read_b128 v[96:99], v44 offset:7184
  s_lshl_b32 s44, s2, 8
  s_add_u32 s44, s44, 2097152
  v_add_u32 v45, s44, v7
  s_waitcnt lgkmcnt(0)
  v_pk_add_f32 v[68:69], v[68:69], v[76:77]
  v_pk_add_f32 v[84:85], v[84:85], v[92:93]
  v_pk_add_f32 v[70:71], v[70:71], v[78:79]
  v_pk_add_f32 v[86:87], v[86:87], v[94:95]
  v_pk_add_f32 v[72:73], v[72:73], v[80:81]
  v_pk_add_f32 v[88:89], v[88:89], v[96:97]
  v_pk_add_f32 v[74:75], v[74:75], v[82:83]
  v_pk_add_f32 v[90:91], v[90:91], v[98:99]
  v_pk_add_f32 v[68:69], v[68:69], v[84:85]
  v_pk_add_f32 v[70:71], v[70:71], v[86:87]
  v_pk_add_f32 v[72:73], v[72:73], v[88:89]
  v_pk_add_f32 v[74:75], v[74:75], v[90:91]
  v_cvt_pk_bf16_f32 v116, v68, v69
  v_cvt_pk_bf16_f32 v117, v70, v71
  v_cvt_pk_bf16_f32 v118, v72, v73
  v_cvt_pk_bf16_f32 v119, v74, v75
  v_cmp_eq_u32 s[64:65], -1, v116
  v_cmp_eq_u32 s[66:67], -1, v117
  v_cmp_eq_u32 s[68:69], -1, v118
  v_cmp_eq_u32 s[70:71], -1, v119
  v_cndmask_b32 v116, v116, v104, s[64:65]
  v_cndmask_b32 v117, v117, v104, s[66:67]
  v_cndmask_b32 v118, v118, v104, s[68:69]
  v_cndmask_b32 v119, v119, v104, s[70:71]
  global_store_dwordx4 v45, v[116:119], s[28:29] sc1
  s_mov_b64 exec, 1
  global_store_byte v52, v47, s[26:27] sc1
  s_mov_b64 exec, -1
L_noq:
  v_lshrrev_b32 v44, 4, v2
  v_bfe_u32 v45, v2, 1, 3
  v_xor_b32 v45, v45, v44
  v_and_b32 v46, 1, v2
  v_lshlrev_b32 v46, 4, v46
  v_lshl_add_u32 v46, v44, 10, v46
  v_lshl_add_u32 v126, v45, 5, v46
  v_xor_b32 v127, 128, v126
  v_bfe_u32 v45, v2, 2, 2
  v_lshl_add_u32 v46, v44, 3, v45
  v_lshlrev_b32 v46, 8, v46
  v_and_b32 v47, 3, v2
  v_lshl_add_u32 v46, v47, 3, v46
  s_lshl_b32 s44, s62, 15
  s_add_u32 s44, s44, 20480
  v_add_u32 v46, s44, v46
  v_bfe_u32 v47, v2, 2, 3
  v_xor_b32 v48, 0, v47
  v_lshl_add_u32 v20, v48, 5, v46
  v_xor_b32 v48, 1, v47
  v_lshl_add_u32 v21, v48, 5, v46
  v_xor_b32 v48, 2, v47
  v_lshl_add_u32 v22, v48, 5, v46
  v_xor_b32 v48, 3, v47
  v_lshl_add_u32 v23, v48, 5, v46
  v_xor_b32 v48, 4, v47
  v_lshl_add_u32 v24, v48, 5, v46
  v_xor_b32 v48, 5, v47
  v_lshl_add_u32 v25, v48, 5, v46
  v_xor_b32 v48, 6, v47
  v_lshl_add_u32 v26, v48, 5, v46
  v_xor_b32 v48, 7, v47
  v_lshl_add_u32 v27, v48, 5, v46
  s_lshl_b32 s44, s62, 8
  s_add_u32 s44, s44, 19456
  v_lshlrev_b32 v3, 2, v2
  v_add_u32 v3, s44, v3
  v_lshlrev_b32 v5, 4, v44
  v_add_u32 v5, s44, v5
  s_mov_b64 s[36:37], s[12:13]
  s_lshl_b32 s53, s61, 17
  s_lshl_b32 s44, s62, 8
  s_add_u32 s53, s53, s44
  s_lshl_b32 s43, s62, 15
  s_add_u32 s43, s43, 20480
  s_add_u32 m0, s43, 0
  s_add_u32 s44, s53, 0
  buffer_load_dwordx4 v126, s[36:39], s44 offen  lds
  s_add_u32 m0, s43, 1024
  s_add_u32 s44, s53, 4096
  buffer_load_dwordx4 v126, s[36:39], s44 offen  lds
  s_add_u32 m0, s43, 2048
  s_add_u32 s44, s53, 8192
  buffer_load_dwordx4 v127, s[36:39], s44 offen  lds
  s_add_u32 m0, s43, 3072
  s_add_u32 s44, s53, 12288
  buffer_load_dwordx4 v127, s[36:39], s44 offen  lds
  s_add_u32 m0, s43, 4096
  s_add_u32 s44, s53, 16384
  buffer_load_dwordx4 v126, s[36:39], s44 offen  lds
  s_add_u32 m0, s43, 5120
  s_add_u32 s44, s53, 20480
  buffer_load_dwordx4 v126, s[36:39], s44 offen  lds
  s_add_u32 m0, s43, 6144
  s_add_u32 s44, s53, 24576
  buffer_load_dwordx4 v127, s[36:39], s44 offen  lds
  s_add_u32 m0, s43, 7168
  s_add_u32 s44, s53, 28672
  buffer_load_dwordx4 v127, s[36:39], s44 offen  lds
  s_waitcnt vmcnt(0)
  s_add_u32 m0, s43, 8192
  s_add_u32 s44, s53, 32768
  buffer_load_dwordx4 v126, s[36:39], s44 offen  lds
  s_add_u32 m0, s43, 9216
  s_add_u32 s44, s53, 36864
  buffer_load_dwordx4 v126, s[36:39], s44 offen  lds
  s_add_u32 m0, s43, 10240
  s_add_u32 s44, s53, 40960
  buffer_load_dwordx4 v127, s[36:39], s44 offen  lds
  s_add_u32 m0, s43, 11264
  s_add_u32 s44, s53, 45056
  buffer_load_dwordx4 v127, s[36:39], s44 offen  lds
  s_add_u32 m0, s43, 12288
  s_add_u32 s44, s53, 49152
  buffer_load_dwordx4 v126, s[36:39], s44 offen  lds
  s_add_u32 m0, s43, 13312
  s_add_u32 s44, s53, 53248
  buffer_load_dwordx4 v126, s[36:39], s44 offen  lds
  s_add_u32 m0, s43, 14336
  s_add_u32 s44, s53, 57344
  buffer_load_dwordx4 v127, s[36:39], s44 offen  lds
  s_add_u32 m0, s43, 15360
  s_add_u32 s44, s53, 61440
  buffer_load_dwordx4 v127, s[36:39], s44 offen  lds
  s_waitcnt vmcnt(0)
  s_add_u32 m0, s43, 16384
  s_add_u32 s44, s53, 65536
  buffer_load_dwordx4 v126, s[36:39], s44 offen  lds
  s_add_u32 m0, s43, 17408
  s_add_u32 s44, s53, 69632
  buffer_load_dwordx4 v126, s[36:39], s44 offen  lds
  s_add_u32 m0, s43, 18432
  s_add_u32 s44, s53, 73728
  buffer_load_dwordx4 v127, s[36:39], s44 offen  lds
  s_add_u32 m0, s43, 19456
  s_add_u32 s44, s53, 77824
  buffer_load_dwordx4 v127, s[36:39], s44 offen  lds
  s_add_u32 m0, s43, 20480
  s_add_u32 s44, s53, 81920
  buffer_load_dwordx4 v126, s[36:39], s44 offen  lds
  s_add_u32 m0, s43, 21504
  s_add_u32 s44, s53, 86016
  buffer_load_dwordx4 v126, s[36:39], s44 offen  lds
  s_add_u32 m0, s43, 22528
  s_add_u32 s44, s53, 90112
  buffer_load_dwordx4 v127, s[36:39], s44 offen  lds
  s_add_u32 m0, s43, 23552
  s_add_u32 s44, s53, 94208
  buffer_load_dwordx4 v127, s[36:39], s44 offen  lds
  s_waitcnt vmcnt(0)
  s_add_u32 m0, s43, 24576
  s_add_u32 s44, s53, 98304
  buffer_load_dwordx4 v126, s[36:39], s44 offen  lds
  s_add_u32 m0, s43, 25600
  s_add_u32 s44, s53, 102400
  buffer_load_dwordx4 v126, s[36:39], s44 offen  lds
  s_add_u32 m0, s43, 26624
  s_add_u32 s44, s53, 106496
  buffer_load_dwordx4 v127, s[36:39], s44 offen  lds
  s_add_u32 m0, s43, 27648
  s_add_u32 s44, s53, 110592
  buffer_load_dwordx4 v127, s[36:39], s44 offen  lds
  s_add_u32 m0, s43, 28672
  s_add_u32 s44, s53, 114688
  buffer_load_dwordx4 v126, s[36:39], s44 offen  lds
  s_add_u32 m0, s43, 29696
  s_add_u32 s44, s53, 118784
  buffer_load_dwordx4 v126, s[36:39], s44 offen  lds
  s_add_u32 m0, s43, 30720
  s_add_u32 s44, s53, 122880
  buffer_load_dwordx4 v127, s[36:39], s44 offen  lds
  s_add_u32 m0, s43, 31744
  s_add_u32 s44, s53, 126976
  buffer_load_dwordx4 v127, s[36:39], s44 offen  lds
  s_waitcnt vmcnt(0)
  s_waitcnt vmcnt(0)
  ds_read_b64_tr_b16 v[128:129], v20 offset:0
  ds_read_b64_tr_b16 v[130:131], v20 offset:1024
  ds_read_b64_tr_b16 v[132:133], v20 offset:8192
  ds_read_b64_tr_b16 v[134:135], v20 offset:9216
  ds_read_b64_tr_b16 v[136:137], v20 offset:16384
  ds_read_b64_tr_b16 v[138:139], v20 offset:17408
  ds_read_b64_tr_b16 v[140:141], v20 offset:24576
  ds_read_b64_tr_b16 v[142:143], v20 offset:25600
  ds_read_b64_tr_b16 v[144:145], v21 offset:0
  ds_read_b64_tr_b16 v[146:147], v21 offset:1024
  ds_read_b64_tr_b16 v[148:149], v21 offset:8192
  ds_read_b64_tr_b16 v[150:151], v21 offset:9216
  ds_read_b64_tr_b16 v[152:153], v21 offset:16384
  ds_read_b64_tr_b16 v[154:155], v21 offset:17408
  ds_read_b64_tr_b16 v[156:157], v21 offset:24576
  ds_read_b64_tr_b16 v[158:159], v21 offset:25600
  s_waitcnt lgkmcnt(0)
  ds_read_b64_tr_b16 v[160:161], v22 offset:0
  ds_read_b64_tr_b16 v[162:163], v22 offset:1024
  ds_read_b64_tr_b16 v[164:165], v22 offset:8192
  ds_read_b64_tr_b16 v[166:167], v22 offset:9216
  ds_read_b64_tr_b16 v[168:169], v22 offset:16384
  ds_read_b64_tr_b16 v[170:171], v22 offset:17408
  ds_read_b64_tr_b16 v[172:173], v22 offset:24576
  ds_read_b64_tr_b16 v[174:175], v22 offset:25600
  ds_read_b64_tr_b16 v[176:177], v23 offset:0
  ds_read_b64_tr_b16 v[178:179], v23 offset:1024
  ds_read_b64_tr_b16 v[180:181], v23 offset:8192
  ds_read_b64_tr_b16 v[182:183], v23 offset:9216
  ds_read_b64_tr_b16 v[184:185], v23 offset:16384
  ds_read_b64_tr_b16 v[186:187], v23 offset:17408
  ds_read_b64_tr_b16 v[188:189], v23 offset:24576
  ds_read_b64_tr_b16 v[190:191], v23 offset:25600
  s_waitcnt lgkmcnt(0)
  ds_read_b64_tr_b16 v[192:193], v24 offset:0
  ds_read_b64_tr_b16 v[194:195], v24 offset:1024
  ds_read_b64_tr_b16 v[196:197], v24 offset:8192
  ds_read_b64_tr_b16 v[198:199], v24 offset:9216
  ds_read_b64_tr_b16 v[200:201], v24 offset:16384
  ds_read_b64_tr_b16 v[202:203], v24 offset:17408
  ds_read_b64_tr_b16 v[204:205], v24 offset:24576
  ds_read_b64_tr_b16 v[206:207], v24 offset:25600
  ds_read_b64_tr_b16 v[208:209], v25 offset:0
  ds_read_b64_tr_b16 v[210:211], v25 offset:1024
  ds_read_b64_tr_b16 v[212:213], v25 offset:8192
  ds_read_b64_tr_b16 v[214:215], v25 offset:9216
  ds_read_b64_tr_b16 v[216:217], v25 offset:16384
  ds_read_b64_tr_b16 v[218:219], v25 offset:17408
  ds_read_b64_tr_b16 v[220:221], v25 offset:24576
  ds_read_b64_tr_b16 v[222:223], v25 offset:25600
  s_waitcnt lgkmcnt(0)
  ds_read_b64_tr_b16 v[224:225], v26 offset:0
  ds_read_b64_tr_b16 v[226:227], v26 offset:1024
  ds_read_b64_tr_b16 v[228:229], v26 offset:8192
  ds_read_b64_tr_b16 v[230:231], v26 offset:9216
  ds_read_b64_tr_b16 v[232:233], v26 offset:16384
  ds_read_b64_tr_b16 v[234:235], v26 offset:17408
  ds_read_b64_tr_b16 v[236:237], v26 offset:24576
  ds_read_b64_tr_b16 v[238:239], v26 offset:25600
  ds_read_b64_tr_b16 v[240:241], v27 offset:0
  ds_read_b64_tr_b16 v[242:243], v27 offset:1024
  ds_read_b64_tr_b16 v[244:245], v27 offset:8192
  ds_read_b64_tr_b16 v[246:247], v27 offset:9216
  ds_read_b64_tr_b16 v[248:249], v27 offset:16384
  ds_read_b64_tr_b16 v[250:251], v27 offset:17408
  ds_read_b64_tr_b16 v[252:253], v27 offset:24576
  ds_read_b64_tr_b16 v[254:255], v27 offset:25600
  s_waitcnt lgkmcnt(0)
  s_mov_b64 s[36:37], s[22:23]
  s_lshl_b32 s53, s31, 17
  s_lshl_b32 s44, s62, 8
  s_add_u32 s53, s53, s44
  s_lshl_b32 s43, s62, 15
  s_add_u32 s43, s43, 20480
  s_add_u32 m0, s43, 0
  s_add_u32 s44, s53, 0
  buffer_load_dwordx4 v126, s[36:39], s44 offen  lds
  s_add_u32 m0, s43, 1024
  s_add_u32 s44, s53, 4096
  buffer_load_dwordx4 v126, s[36:39], s44 offen  lds
  s_add_u32 m0, s43, 2048
  s_add_u32 s44, s53, 8192
  buffer_load_dwordx4 v127, s[36:39], s44 offen  lds
  s_add_u32 m0, s43, 3072
  s_add_u32 s44, s53, 12288
  buffer_load_dwordx4 v127, s[36:39], s44 offen  lds
  s_add_u32 m0, s43, 4096
  s_add_u32 s44, s53, 16384
  buffer_load_dwordx4 v126, s[36:39], s44 offen  lds
  s_add_u32 m0, s43, 5120
  s_add_u32 s44, s53, 20480
  buffer_load_dwordx4 v126, s[36:39], s44 offen  lds
  s_add_u32 m0, s43, 6144
  s_add_u32 s44, s53, 24576
  buffer_load_dwordx4 v127, s[36:39], s44 offen  lds
  s_add_u32 m0, s43, 7168
  s_add_u32 s44, s53, 28672
  buffer_load_dwordx4 v127, s[36:39], s44 offen  lds
  s_waitcnt vmcnt(0)
  s_add_u32 m0, s43, 8192
  s_add_u32 s44, s53, 32768
  buffer_load_dwordx4 v126, s[36:39], s44 offen  lds
  s_add_u32 m0, s43, 9216
  s_add_u32 s44, s53, 36864
  buffer_load_dwordx4 v126, s[36:39], s44 offen  lds
  s_add_u32 m0, s43, 10240
  s_add_u32 s44, s53, 40960
  buffer_load_dwordx4 v127, s[36:39], s44 offen  lds
  s_add_u32 m0, s43, 11264
  s_add_u32 s44, s53, 45056
  buffer_load_dwordx4 v127, s[36:39], s44 offen  lds
  s_add_u32 m0, s43, 12288
  s_add_u32 s44, s53, 49152
  buffer_load_dwordx4 v126, s[36:39], s44 offen  lds
  s_add_u32 m0, s43, 13312
  s_add_u32 s44, s53, 53248
  buffer_load_dwordx4 v126, s[36:39], s44 offen  lds
  s_add_u32 m0, s43, 14336
  s_add_u32 s44, s53, 57344
  buffer_load_dwordx4 v127, s[36:39], s44 offen  lds
  s_add_u32 m0, s43, 15360
  s_add_u32 s44, s53, 61440
  buffer_load_dwordx4 v127, s[36:39], s44 offen  lds
  s_waitcnt vmcnt(0)
  s_add_u32 m0, s43, 16384
  s_add_u32 s44, s53, 65536
  buffer_load_dwordx4 v126, s[36:39], s44 offen  lds
  s_add_u32 m0, s43, 17408
  s_add_u32 s44, s53, 69632
  buffer_load_dwordx4 v126, s[36:39], s44 offen  lds
  s_add_u32 m0, s43, 18432
  s_add_u32 s44, s53, 73728
  buffer_load_dwordx4 v127, s[36:39], s44 offen  lds
  s_add_u32 m0, s43, 19456
  s_add_u32 s44, s53, 77824
  buffer_load_dwordx4 v127, s[36:39], s44 offen  lds
  s_add_u32 m0, s43, 20480
  s_add_u32 s44, s53, 81920
  buffer_load_dwordx4 v126, s[36:39], s44 offen  lds
  s_add_u32 m0, s43, 21504
  s_add_u32 s44, s53, 86016
  buffer_load_dwordx4 v126, s[36:39], s44 offen  lds
  s_add_u32 m0, s43, 22528
  s_add_u32 s44, s53, 90112
  buffer_load_dwordx4 v127, s[36:39], s44 offen  lds
  s_add_u32 m0, s43, 23552
  s_add_u32 s44, s53, 94208
  buffer_load_dwordx4 v127, s[36:39], s44 offen  lds
  s_waitcnt vmcnt(0)
  s_add_u32 m0, s43, 24576
  s_add_u32 s44, s53, 98304
  buffer_load_dwordx4 v126, s[36:39], s44 offen  lds
  s_add_u32 m0, s43, 25600
  s_add_u32 s44, s53, 102400
  buffer_load_dwordx4 v126, s[36:39], s44 offen  lds
  s_add_u32 m0, s43, 26624
  s_add_u32 s44, s53, 106496
  buffer_load_dwordx4 v127, s[36:39], s44 offen  lds
  s_add_u32 m0, s43, 27648
  s_add_u32 s44, s53, 110592
  buffer_load_dwordx4 v127, s[36:39], s44 offen  lds
  s_add_u32 m0, s43, 28672
  s_add_u32 s44, s53, 114688
  buffer_load_dwordx4 v126, s[36:39], s44 offen  lds
  s_add_u32 m0, s43, 29696
  s_add_u32 s44, s53, 118784
  buffer_load_dwordx4 v126, s[36:39], s44 offen  lds
  s_add_u32 m0, s43, 30720
  s_add_u32 s44, s53, 122880
  buffer_load_dwordx4 v127, s[36:39], s44 offen  lds
  s_add_u32 m0, s43, 31744
  s_add_u32 s44, s53, 126976
  buffer_load_dwordx4 v127, s[36:39], s44 offen  lds
  s_waitcnt vmcnt(0)
  s_cmp_lg_u32 s62, 0
  s_cbranch_scc1 L_qbdone
  s_sleep 127
  s_mov_b32 s44, 65536
  s_branch L_z1
L_z:
  s_sleep 48
L_z1:
  s_load_dwordx8 s[64:71], s[54:55], 0x0 glc
  s_sub_u32 s44, s44, 1
  s_waitcnt lgkmcnt(0)
  s_cbranch_scc1 L_zx
  s_and_b64 s[64:65], s[64:65], s[66:67]
  s_and_b64 s[68:69], s[68:69], s[70:71]
  s_and_b64 s[64:65], s[64:65], s[68:69]
  s_and_b32 s64, s64, s65
  s_cmp_lg_u32 s64, 0x01010101
  s_cbranch_scc1 L_z
L_zx:
  s_andn2_b32 s44, s2, 3
  s_lshl_b32 s44, s44, 8
  s_add_u32 s44, s44, 2097152
  v_add_u32 v45, s44, v7
  s_mov_b64 s[56:57], exec
  s_mov_b32 s44, 65536
L_gq:
  global_load_dwordx4 v[68:71], v45, s[28:29] sc1
  s_sub_u32 s44, s44, 1
  s_cbranch_scc1 L_gxq
  s_waitcnt vmcnt(0)
  v_max3_u32 v44, v68, v69, v70
  v_max_u32 v44, v44, v71
  v_cmp_eq_u32 vcc, -1, v44
  s_nop 0
  s_cbranch_vccz L_gxq
  s_mov_b64 exec, vcc
  s_sleep 48
  s_branch L_gq
L_gxq:
  s_mov_b64 exec, s[56:57]
  s_waitcnt vmcnt(0)
  ds_write_b128 v7, v[68:71] offset:2048
L_qbdone:
  s_waitcnt lgkmcnt(0)
  s_mov_b64 exec, -1
  s_mov_b64 s[74:75], -1
  s_mov_b32 s76, -1
  s_mov_b32 s77, 1
  s_mov_b32 s78, 0
  s_mov_b32 s79, 1
  s_mov_b32 s45, 0
  s_waitcnt vmcnt(0) lgkmcnt(0)
  s_barrier
  s_barrier
  ds_read_b128 v[52:55], v102 offset:5120
  ds_read_b128 v[56:59], v102 offset:5136
  ds_read_b64 v[68:69], v100 offset:3072
  ds_read_b64 v[70:71], v100 offset:3584
  ds_read_b64 v[72:73], v100 offset:4096
  ds_read_b64 v[74:75], v100 offset:4608
  s_waitcnt lgkmcnt(4)
L_project:
  v_max3_f32 v64, v52, v53, v54
  v_max_f32 v64, v64, v55
  v_sub_f32 v60, v52, v64
  v_sub_f32 v61, v53, v64
  v_sub_f32 v62, v54, v64
  v_sub_f32 v63, v55, v64
  v_exp_f32 v60, v60
  v_exp_f32 v61, v61
  v_exp_f32 v62, v62
  v_exp_f32 v63, v63
  s_nop 0
  v_mul_f32 v65, v60, v56
  v_fmac_f32 v65, v61, v57
  v_fmac_f32 v65, v62, v58
  v_fmac_f32 v65, v63, v59
  v_rcp_f32 v65, v65
  s_nop 0
  v_mul_f32 v60, v60, v65
  v_mul_f32 v61, v61, v65
  v_mul_f32 v62, v62, v65
  v_mul_f32 v63, v63, v65
  s_waitcnt lgkmcnt(0)
  v_mul_f32 v68, v60, v68
  v_mul_f32 v69, v60, v69
  v_fmac_f32 v68, v61, v70
  v_fmac_f32 v69, v61, v71
  v_fmac_f32 v68, v62, v72
  v_fmac_f32 v69, v62, v73
  v_fmac_f32 v68, v63, v74
  v_fmac_f32 v69, v63, v75
  v_cvt_pk_bf16_f32 v68, v68, v69
  ds_write_b32 v3, v68
  s_waitcnt lgkmcnt(0)
  ds_read_b128 v[28:31], v5 offset:0
  ds_read_b128 v[32:35], v5 offset:64
  ds_read_b128 v[36:39], v5 offset:128
  ds_read_b128 v[40:43], v5 offset:192
  s_waitcnt lgkmcnt(3)
  v_mfma_f32_16x16x32_bf16 v[68:71], v[28:31], v[128:131], 0
  v_mfma_f32_16x16x32_bf16 v[72:75], v[28:31], v[144:147], 0
  v_mfma_f32_16x16x32_bf16 v[76:79], v[28:31], v[160:163], 0
  v_mfma_f32_16x16x32_bf16 v[80:83], v[28:31], v[176:179], 0
  v_mfma_f32_16x16x32_bf16 v[84:87], v[28:31], v[192:195], 0
  v_mfma_f32_16x16x32_bf16 v[88:91], v[28:31], v[208:211], 0
  v_mfma_f32_16x16x32_bf16 v[92:95], v[28:31], v[224:227], 0
  v_mfma_f32_16x16x32_bf16 v[96:99], v[28:31], v[240:243], 0
  s_waitcnt lgkmcnt(2)
  v_mfma_f32_16x16x32_bf16 v[68:71], v[32:35], v[132:135], v[68:71]
  v_mfma_f32_16x16x32_bf16 v[72:75], v[32:35], v[148:151], v[72:75]
  v_mfma_f32_16x16x32_bf16 v[76:79], v[32:35], v[164:167], v[76:79]
  v_mfma_f32_16x16x32_bf16 v[80:83], v[32:35], v[180:183], v[80:83]
  v_mfma_f32_16x16x32_bf16 v[84:87], v[32:35], v[196:199], v[84:87]
  v_mfma_f32_16x16x32_bf16 v[88:91], v[32:35], v[212:215], v[88:91]
  v_mfma_f32_16x16x32_bf16 v[92:95], v[32:35], v[228:231], v[92:95]
  v_mfma_f32_16x16x32_bf16 v[96:99], v[32:35], v[244:247], v[96:99]
  s_waitcnt lgkmcnt(1)
  v_mfma_f32_16x16x32_bf16 v[68:71], v[36:39], v[136:139], v[68:71]
  v_mfma_f32_16x16x32_bf16 v[72:75], v[36:39], v[152:155], v[72:75]
  v_mfma_f32_16x16x32_bf16 v[76:79], v[36:39], v[168:171], v[76:79]
  v_mfma_f32_16x16x32_bf16 v[80:83], v[36:39], v[184:187], v[80:83]
  v_mfma_f32_16x16x32_bf16 v[84:87], v[36:39], v[200:203], v[84:87]
  v_mfma_f32_16x16x32_bf16 v[88:91], v[36:39], v[216:219], v[88:91]
  v_mfma_f32_16x16x32_bf16 v[92:95], v[36:39], v[232:235], v[92:95]
  v_mfma_f32_16x16x32_bf16 v[96:99], v[36:39], v[248:251], v[96:99]
  s_waitcnt lgkmcnt(0)
  v_mfma_f32_16x16x32_bf16 v[68:71], v[40:43], v[140:143], v[68:71]
  v_mfma_f32_16x16x32_bf16 v[72:75], v[40:43], v[156:159], v[72:75]
  v_mfma_f32_16x16x32_bf16 v[76:79], v[40:43], v[172:175], v[76:79]
  v_mfma_f32_16x16x32_bf16 v[80:83], v[40:43], v[188:191], v[80:83]
  v_mfma_f32_16x16x32_bf16 v[84:87], v[40:43], v[204:207], v[84:87]
  v_mfma_f32_16x16x32_bf16 v[88:91], v[40:43], v[220:223], v[88:91]
  v_mfma_f32_16x16x32_bf16 v[92:95], v[40:43], v[236:239], v[92:95]
  v_mfma_f32_16x16x32_bf16 v[96:99], v[40:43], v[252:255], v[96:99]
  s_nop 2
  s_cmp_lg_u32 s45, 0
  s_cbranch_scc1 L_tail
  v_mov_b32_dpp v112, v68 quad_perm:[0,1,2,3] row_mask:0x1 bank_mask:0xf
  v_mov_b32_dpp v113, v72 quad_perm:[0,1,2,3] row_mask:0x1 bank_mask:0xf
  v_mov_b32_dpp v112, v76 quad_perm:[0,1,2,3] row_mask:0x2 bank_mask:0xf
  v_mov_b32_dpp v113, v80 quad_perm:[0,1,2,3] row_mask:0x2 bank_mask:0xf
  v_mov_b32_dpp v112, v84 quad_perm:[0,1,2,3] row_mask:0x4 bank_mask:0xf
  v_mov_b32_dpp v113, v88 quad_perm:[0,1,2,3] row_mask:0x4 bank_mask:0xf
  v_mov_b32_dpp v112, v92 quad_perm:[0,1,2,3] row_mask:0x8 bank_mask:0xf
  v_mov_b32_dpp v113, v96 quad_perm:[0,1,2,3] row_mask:0x8 bank_mask:0xf
  ds_read_b64_tr_b16 v[128:129], v20 offset:0
  ds_read_b64_tr_b16 v[130:131], v20 offset:1024
  ds_read_b64_tr_b16 v[132:133], v20 offset:8192
  ds_read_b64_tr_b16 v[134:135], v20 offset:9216
  ds_read_b64_tr_b16 v[136:137], v20 offset:16384
  ds_read_b64_tr_b16 v[138:139], v20 offset:17408
  ds_read_b64_tr_b16 v[140:141], v20 offset:24576
  ds_read_b64_tr_b16 v[142:143], v20 offset:25600
  ds_read_b64_tr_b16 v[144:145], v21 offset:0
  ds_read_b64_tr_b16 v[146:147], v21 offset:1024
  ds_read_b64_tr_b16 v[148:149], v21 offset:8192
  ds_read_b64_tr_b16 v[150:151], v21 offset:9216
  ds_read_b64_tr_b16 v[152:153], v21 offset:16384
  ds_read_b64_tr_b16 v[154:155], v21 offset:17408
  ds_read_b64_tr_b16 v[156:157], v21 offset:24576
  ds_read_b64_tr_b16 v[158:159], v21 offset:25600
  s_waitcnt lgkmcnt(0)
  ds_read_b64_tr_b16 v[160:161], v22 offset:0
  ds_read_b64_tr_b16 v[162:163], v22 offset:1024
  ds_read_b64_tr_b16 v[164:165], v22 offset:8192
  ds_read_b64_tr_b16 v[166:167], v22 offset:9216
  ds_read_b64_tr_b16 v[168:169], v22 offset:16384
  ds_read_b64_tr_b16 v[170:171], v22 offset:17408
  ds_read_b64_tr_b16 v[172:173], v22 offset:24576
  ds_read_b64_tr_b16 v[174:175], v22 offset:25600
  ds_read_b64_tr_b16 v[176:177], v23 offset:0
  ds_read_b64_tr_b16 v[178:179], v23 offset:1024
  ds_read_b64_tr_b16 v[180:181], v23 offset:8192
  ds_read_b64_tr_b16 v[182:183], v23 offset:9216
  ds_read_b64_tr_b16 v[184:185], v23 offset:16384
  ds_read_b64_tr_b16 v[186:187], v23 offset:17408
  ds_read_b64_tr_b16 v[188:189], v23 offset:24576
  ds_read_b64_tr_b16 v[190:191], v23 offset:25600
  s_waitcnt lgkmcnt(0)
  ds_read_b64_tr_b16 v[192:193], v24 offset:0
  ds_read_b64_tr_b16 v[194:195], v24 offset:1024
  ds_read_b64_tr_b16 v[196:197], v24 offset:8192
  ds_read_b64_tr_b16 v[198:199], v24 offset:9216
  ds_read_b64_tr_b16 v[200:201], v24 offset:16384
  ds_read_b64_tr_b16 v[202:203], v24 offset:17408
  ds_read_b64_tr_b16 v[204:205], v24 offset:24576
  ds_read_b64_tr_b16 v[206:207], v24 offset:25600
  ds_read_b64_tr_b16 v[208:209], v25 offset:0
  ds_read_b64_tr_b16 v[210:211], v25 offset:1024
  ds_read_b64_tr_b16 v[212:213], v25 offset:8192
  ds_read_b64_tr_b16 v[214:215], v25 offset:9216
  ds_read_b64_tr_b16 v[216:217], v25 offset:16384
  ds_read_b64_tr_b16 v[218:219], v25 offset:17408
  ds_read_b64_tr_b16 v[220:221], v25 offset:24576
  ds_read_b64_tr_b16 v[222:223], v25 offset:25600
  s_waitcnt lgkmcnt(0)
  ds_read_b64_tr_b16 v[224:225], v26 offset:0
  ds_read_b64_tr_b16 v[226:227], v26 offset:1024
  ds_read_b64_tr_b16 v[228:229], v26 offset:8192
  ds_read_b64_tr_b16 v[230:231], v26 offset:9216
  ds_read_b64_tr_b16 v[232:233], v26 offset:16384
  ds_read_b64_tr_b16 v[234:235], v26 offset:17408
  ds_read_b64_tr_b16 v[236:237], v26 offset:24576
  ds_read_b64_tr_b16 v[238:239], v26 offset:25600
  ds_read_b64_tr_b16 v[240:241], v27 offset:0
  ds_read_b64_tr_b16 v[242:243], v27 offset:1024
  ds_read_b64_tr_b16 v[244:245], v27 offset:8192
  ds_read_b64_tr_b16 v[246:247], v27 offset:9216
  ds_read_b64_tr_b16 v[248:249], v27 offset:16384
  ds_read_b64_tr_b16 v[250:251], v27 offset:17408
  ds_read_b64_tr_b16 v[252:253], v27 offset:24576
  ds_read_b64_tr_b16 v[254:255], v27 offset:25600
  s_waitcnt lgkmcnt(0)
  s_mov_b32 s45, 1
  s_barrier
L_stage1:
  ds_read_b128 v[52:55], v105 offset:5184
  ds_read_b128 v[56:59], v105 offset:5200
  ds_read_b128 v[68:71], v101 offset:8192
  ds_read_b128 v[72:75], v101 offset:10240
  ds_read_b128 v[76:79], v101 offset:12288
  ds_read_b128 v[80:83], v101 offset:14336
  s_waitcnt lgkmcnt(4)
  v_max3_f32 v64, v52, v53, v54
  v_max_f32 v64, v64, v55
  v_sub_f32 v60, v52, v64
  v_sub_f32 v61, v53, v64
  v_sub_f32 v62, v54, v64
  v_sub_f32 v63, v55, v64
  v_exp_f32 v60, v60
  v_exp_f32 v61, v61
  v_exp_f32 v62, v62
  v_exp_f32 v63, v63
  s_nop 0
  v_mul_f32 v65, v60, v56
  v_fmac_f32 v65, v61, v57
  v_fmac_f32 v65, v62, v58
  v_fmac_f32 v65, v63, v59
  s_waitcnt lgkmcnt(0)
  v_mul_f32 v68, v60, v68
  v_mul_f32 v69, v60, v69
  v_mul_f32 v70, v60, v70
  v_mul_f32 v71, v60, v71
  v_fmac_f32 v68, v61, v72
  v_fmac_f32 v69, v61, v73
  v_fmac_f32 v70, v61, v74
  v_fmac_f32 v71, v61, v75
  v_fmac_f32 v68, v62, v76
  v_fmac_f32 v69, v62, v77
  v_fmac_f32 v70, v62, v78
  v_fmac_f32 v71, v62, v79
  v_fmac_f32 v68, v63, v80
  v_fmac_f32 v69, v63, v81
  v_fmac_f32 v70, v63, v82
  v_fmac_f32 v71, v63, v83
  s_mov_b64 exec, s[78:79]
  v_mov_b32 v68, v64
  v_mov_b32 v69, v65
  s_mov_b64 exec, s[76:77]
  v_cmp_eq_u32 s[64:65], -1, v68
  v_cmp_eq_u32 s[66:67], -1, v69
  v_cmp_eq_u32 s[68:69], -1, v70
  v_cmp_eq_u32 s[70:71], -1, v71
  v_cndmask_b32 v68, v68, v104, s[64:65]
  v_cndmask_b32 v69, v69, v104, s[66:67]
  v_cndmask_b32 v70, v70, v104, s[68:69]
  v_cndmask_b32 v71, v71, v104, s[70:71]
  global_store_dwordx4 v17, v[68:71], s[28:29] sc1
  s_mov_b64 s[56:57], exec
  s_mov_b32 s44, 65536
L_gp:
  global_load_dwordx4 v[72:75], v16, s[28:29] sc1
  s_sub_u32 s44, s44, 1
  s_cbranch_scc1 L_gxp
  s_waitcnt vmcnt(0)
  v_max3_u32 v44, v72, v73, v74
  v_max_u32 v44, v44, v75
  v_cmp_eq_u32 vcc, -1, v44
  s_nop 0
  s_cbranch_vccz L_gxp
  s_mov_b64 exec, vcc
  s_bcnt1_i32_b64 s43, vcc
  s_cmp_gt_u32 s43, 64
  s_cbranch_scc1 L_glp
  s_sleep 1
  s_branch L_gp
L_glp:
  s_sleep 16
  s_branch L_gp
L_gxp:
  s_mov_b64 exec, s[56:57]
  s_waitcnt vmcnt(0)
  ds_write_b128 v125, v[72:75] offset:16384
  s_mov_b64 exec, s[74:75]
  s_waitcnt lgkmcnt(0)
  s_cbranch_execz L_nobar
  s_barrier
L_nobar:
  ds_read_b64 v[76:77], v102 offset:16896
  ds_read_b64 v[78:79], v102 offset:17536
  ds_read_b64 v[80:81], v102 offset:18176
  ds_read_b64 v[82:83], v102 offset:18816
  ds_read_b64 v[68:69], v100 offset:16384
  ds_read_b64 v[70:71], v100 offset:17024
  ds_read_b64 v[72:73], v100 offset:17664
  ds_read_b64 v[74:75], v100 offset:18304
  s_waitcnt lgkmcnt(4)
  v_mov_b32 v52, v76
  v_mov_b32 v56, v77
  v_mov_b32 v53, v78
  v_mov_b32 v57, v79
  v_mov_b32 v54, v80
  v_mov_b32 v58, v81
  v_mov_b32 v55, v82
  v_mov_b32 v59, v83
  s_cbranch_execnz L_project
L_tail:
  v_mov_b32_dpp v114, v68 quad_perm:[0,1,2,3] row_mask:0x1 bank_mask:0xf
  v_mov_b32_dpp v115, v72 quad_perm:[0,1,2,3] row_mask:0x1 bank_mask:0xf
  v_mov_b32_dpp v114, v76 quad_perm:[0,1,2,3] row_mask:0x2 bank_mask:0xf
  v_mov_b32_dpp v115, v80 quad_perm:[0,1,2,3] row_mask:0x2 bank_mask:0xf
  v_mov_b32_dpp v114, v84 quad_perm:[0,1,2,3] row_mask:0x4 bank_mask:0xf
  v_mov_b32_dpp v115, v88 quad_perm:[0,1,2,3] row_mask:0x4 bank_mask:0xf
  v_mov_b32_dpp v114, v92 quad_perm:[0,1,2,3] row_mask:0x8 bank_mask:0xf
  v_mov_b32_dpp v115, v96 quad_perm:[0,1,2,3] row_mask:0x8 bank_mask:0xf
  v_cmp_eq_u32 s[64:65], -1, v112
  v_cmp_eq_u32 s[66:67], -1, v113
  v_cmp_eq_u32 s[68:69], -1, v114
  v_cmp_eq_u32 s[70:71], -1, v115
  v_cndmask_b32 v112, v112, v104, s[64:65]
  v_cndmask_b32 v113, v113, v104, s[66:67]
  v_cndmask_b32 v114, v114, v104, s[68:69]
  v_cndmask_b32 v115, v115, v104, s[70:71]
  global_store_dwordx4 v103, v[112:115], s[28:29] sc1
  s_cmp_lg_u32 s62, 0
  s_cbranch_scc1 L_fin
  s_mov_b64 s[56:57], exec
  s_mov_b32 s44, 65536
L_gy:
  global_load_dwordx4 v[68:71], v120, s[28:29] sc1
  global_load_dwordx4 v[72:75], v121, s[28:29] sc1
  global_load_dwordx4 v[76:79], v122, s[28:29] sc1
  global_load_dwordx4 v[80:83], v123, s[28:29] sc1
  s_sub_u32 s44, s44, 1
  s_cbranch_scc1 L_gxy
  s_waitcnt vmcnt(3)
  v_max3_u32 v44, v68, v69, v70
  v_max_u32 v44, v44, v71
  s_waitcnt vmcnt(2)
  v_max3_u32 v44, v44, v72, v73
  v_max3_u32 v44, v44, v74, v75
  s_waitcnt vmcnt(1)
  v_max3_u32 v44, v44, v76, v77
  v_max3_u32 v44, v44, v78, v79
  s_waitcnt vmcnt(0)
  v_max3_u32 v44, v44, v80, v81
  v_max3_u32 v44, v44, v82, v83
  v_cmp_eq_u32 vcc, -1, v44
  s_nop 0
  s_cbranch_vccz L_gxy
  s_mov_b64 exec, vcc
  s_bcnt1_i32_b64 s43, vcc
  s_cmp_gt_u32 s43, 16
  s_cbranch_scc1 L_gly
  s_sleep 1
  s_branch L_gy
L_gly:
  s_sleep 8
  s_branch L_gy
L_gxy:
  s_mov_b64 exec, s[56:57]
  s_waitcnt vmcnt(0)
  v_pk_add_f32 v[68:69], v[68:69], v[72:73]
  v_pk_add_f32 v[76:77], v[76:77], v[80:81]
  v_pk_add_f32 v[70:71], v[70:71], v[74:75]
  v_pk_add_f32 v[78:79], v[78:79], v[82:83]
  v_pk_add_f32 v[68:69], v[68:69], v[76:77]
  v_pk_add_f32 v[70:71], v[70:71], v[78:79]
  s_nop 0
  v_add_f32_dpp v44, v68, v68 row_ror:8 row_mask:0xf bank_mask:0x3
  v_add_f32_dpp v45, v69, v69 row_ror:8 row_mask:0xf bank_mask:0x3
  v_add_f32_dpp v44, v70, v70 row_ror:8 row_mask:0xf bank_mask:0xc
  v_add_f32_dpp v45, v71, v71 row_ror:8 row_mask:0xf bank_mask:0xc
  s_nop 1
  v_permlane16_swap_b32 v44, v45
  v_add_f32 v44, v44, v45
  v_mov_b32 v45, v44
  s_nop 1
  v_permlane32_swap_b32 v44, v45
  v_add_f32 v44, v44, v45
  v_cvt_pk_bf16_f32 v44, v44, v44
  s_mov_b32 exec_hi, 0
  global_store_short v124, v44, s[24:25]
L_fin:
L_end:
  s_endpgm
.section .rodata,"a"
.p2align 6
.amdhsa_kernel concat_heads__mha_block_cached__gqa_block_cached__decode_kernel
  .amdhsa_next_free_vgpr 256
  .amdhsa_next_free_sgpr 80
  .amdhsa_accum_offset 256
  .amdhsa_group_segment_fixed_size 0
  .amdhsa_kernarg_size 104
  .amdhsa_user_sgpr_count 2
  .amdhsa_user_sgpr_kernarg_segment_ptr 1
  .amdhsa_system_sgpr_workgroup_id_x 1
  .amdhsa_float_denorm_mode_32 3
.end_amdhsa_kernel
```
